```python
import torch

def _softmax(x, axis=-1):
    return torch.softmax(x, dim=axis)
def _gelu(x):
    return torch.nn.functional.gelu(x, approximate="tanh")
def _silu(x):
    return torch.nn.functional.silu(x)
def _sigmoid(x):
    return torch.sigmoid(x)
def _layernorm(x, axis=-1, eps=1e-5):
    m = x.mean(dim=axis, keepdim=True)
    v = x.var(dim=axis, keepdim=True, unbiased=False)
    return (x - m) / torch.sqrt(v + eps)
def _scatter_add(tgt, idx, src, axis=0):
    return tgt.clone().index_add_(axis, idx, src)
def _segment_sum(src, seg, n):
    out = torch.zeros((n,) + src.shape[1:], dtype=src.dtype)
    return out.index_add_(0, seg, src)
def _pad(x, pw):
    flat = tuple(v for pair in reversed(pw) for v in pair)
    return torch.nn.functional.pad(x, flat)

kernel_name = 'recurrent_scan__mha_block__swiglu_ffn__prompt'

def setup_inputs():

    _w = (lambda a: (lambda t: t.to(torch.bfloat16) if t.is_floating_point() else t)(torch.as_tensor(a)))
    def _A_setup():
        B, S, D, H = 1, 2048, 512, 32
        return {
            "x": _w((lambda *s: torch.randn(*s, dtype=torch.bfloat16) * 0.05)(B, S, D)),
            "wqkv": _w((lambda *s: torch.randn(*s, dtype=torch.bfloat16) * 0.05)(D, 3 * D)),
            "wo": _w((lambda *s: torch.randn(*s, dtype=torch.bfloat16) * 0.05)(D, D)),
        }
    _A_in = _A_setup()

    def _B_setup():
        B, S, D, F = 1, 2048, 512, 1792
        return {
            "x": _w((lambda *s: torch.randn(*s, dtype=torch.bfloat16) * 0.05)(B, S, D)),
            "w_gate": _w((lambda *s: torch.randn(*s, dtype=torch.bfloat16) * 0.05)(D, F)),
            "w_up": _w((lambda *s: torch.randn(*s, dtype=torch.bfloat16) * 0.05)(D, F)),
            "w_down": _w((lambda *s: torch.randn(*s, dtype=torch.bfloat16) * 0.05)(F, D)),
        }
    _B_in = _B_setup()

    return {
        "A_x": _A_in["x"],
        "A_wqkv": _A_in["wqkv"],
        "A_wo": _A_in["wo"],
        "B_x": _B_in["x"],
        "B_w_gate": _B_in["w_gate"],
        "B_w_up": _B_in["w_up"],
        "B_w_down": _B_in["w_down"],
    }

def reference(A_x, A_wqkv, A_wo, B_x, B_w_gate, B_w_up, B_w_down):
    def _A_ref(x, wqkv, wo):
        B, S, D = x.shape
        H = 32
        Dh = D // H
        qkv = (lambda x, *d: x.permute(*d))((x @ wqkv).reshape(B, S, 3, H, Dh), 2, 0, 3, 1, 4)
        q, k, v = qkv[0], qkv[1], qkv[2]
        scores = torch.einsum("bhqd,bhkd->bhqk", q, k) * (Dh ** -0.5)
        p = _softmax(scores, axis=-1)
        o = torch.einsum("bhqk,bhkd->bhqd", p, v)
        return (lambda x, *d: x.permute(*d))(o, 0, 2, 1, 3).reshape(B, S, D) @ wo

    def _B_ref(x, w_gate, w_up, w_down):
        g = _silu(x @ w_gate)
        u = x @ w_up
        return (g * u) @ w_down

    x = A_x
    xn = _layernorm(x, axis=-1)
    s = _A_ref(xn, A_wqkv, A_wo)
    g = _silu(_B_ref(xn, B_w_gate, B_w_up, B_w_down))
    return x + s * g
```

```asm
; @launch grid=(256,1,1) block=(512,1,1) lds=163840
.amdgcn_target "amdgcn-amd-amdhsa--gfx950"
.text
.globl recurrent_scan__mha_block__swiglu_ffn__prompt_kernel
.p2align 8
.type recurrent_scan__mha_block__swiglu_ffn__prompt_kernel,@function
recurrent_scan__mha_block__swiglu_ffn__prompt_kernel:
    s_cmp_ge_u32 s2, 256
    s_cbranch_scc1 L_end
    s_load_dwordx4 s[4:7], s[0:1], 0
    s_load_dwordx2 s[8:9], s[0:1], 16
    s_load_dwordx4 s[12:15], s[0:1], 32
    s_load_dwordx4 s[16:19], s[0:1], 48
    s_load_dwordx4 s[68:71], s[0:1], 64
    s_getpc_b64 s[32:33]
L_pc:
    s_mov_b32 s34, L_end-L_pc
    s_mov_b32 s35, 0x20000
    v_lshlrev_b32 v19, 7, v0
    s_bfe_u32 s65, s2, 0x20003
    s_lshl_b32 s65, s65, 14
    v_cmp_gt_u32 vcc, 128, v0
    v_add_u32 v19, s65, v19
    v_mov_b32 v18, 0x40000000
    v_cndmask_b32 v19, v18, v19, vcc
    buffer_load_dword v19, v19, s[32:35], 0 offen
    v_and_b32 v1, 63, v0
    v_lshrrev_b32 v2, 6, v0
    s_and_b32 s65, s2, 7
    v_readfirstlane_b32 s40, v2
    s_lshr_b32 s66, s2, 3
    s_lshl_b32 s93, s65, 2
    s_lshr_b32 s47, s66, 3
    s_add_u32 s93, s93, s47
    s_and_b32 s94, s66, 7
    s_and_b32 s41, s65, 3
    s_lshl_b32 s41, s41, 2
    s_and_b32 s67, s66, 3
    s_add_u32 s41, s41, s67
    s_lshr_b32 s65, s65, 2
    s_lshl_b32 s65, s65, 3
    s_lshr_b32 s47, s66, 2
    s_add_u32 s65, s65, s47
    s_lshr_b32 s42, s65, 1
    s_and_b32 s43, s65, 1
    v_lshrrev_b32 v24, 3, v1
    v_and_b32 v25, 7, v1
    s_lshl_b32 s65, s41, 7
    s_lshl_b32 s66, s40, 4
    s_add_u32 s65, s65, s66
    v_add_u32 v26, s65, v24
    v_lshlrev_b32 v26, 10, v26
    v_lshl_add_u32 v15, v25, 4, v26
    s_mov_b32 s48, 8192
    s_waitcnt lgkmcnt(0)
    s_mov_b32 s20, s4
    s_mov_b32 s21, s5
    s_mov_b32 s22, 0x200000
    s_mov_b32 s23, 0x20000
    buffer_load_dwordx4 v[64:67], v15, s[20:23], 0 offen offset:0
    buffer_load_dwordx4 v[68:71], v15, s[20:23], 0 offen offset:128
    buffer_load_dwordx4 v[72:75], v15, s[20:23], 0 offen offset:256
    buffer_load_dwordx4 v[76:79], v15, s[20:23], 0 offen offset:384
    buffer_load_dwordx4 v[80:83], v15, s[20:23], 0 offen offset:512
    buffer_load_dwordx4 v[84:87], v15, s[20:23], 0 offen offset:640
    buffer_load_dwordx4 v[88:91], v15, s[20:23], 0 offen offset:768
    buffer_load_dwordx4 v[92:95], v15, s[20:23], 0 offen offset:896
    buffer_load_dwordx4 v[96:99], v15, s[20:23], s48 offen offset:0
    buffer_load_dwordx4 v[100:103], v15, s[20:23], s48 offen offset:128
    buffer_load_dwordx4 v[104:107], v15, s[20:23], s48 offen offset:256
    buffer_load_dwordx4 v[108:111], v15, s[20:23], s48 offen offset:384
    buffer_load_dwordx4 v[112:115], v15, s[20:23], s48 offen offset:512
    buffer_load_dwordx4 v[116:119], v15, s[20:23], s48 offen offset:640
    buffer_load_dwordx4 v[120:123], v15, s[20:23], s48 offen offset:768
    buffer_load_dwordx4 v[124:127], v15, s[20:23], s48 offen offset:896
    v_lshrrev_b32 v26, 2, v1
    v_and_b32 v27, 3, v1
    v_mul_u32_u24 v28, 3072, v26
    v_lshl_add_u32 v5, v27, 4, v28
    s_lshr_b32 s65, s40, 2
    s_lshl_b32 s48, s65, 1
    v_xor_b32 v27, s48, v27
    v_mul_u32_u24 v28, 3584, v26
    v_lshl_add_u32 v6, v27, 4, v28
    v_xor_b32 v17, 32, v6
    s_and_b32 s67, s40, 3
    s_lshl_b32 s44, s65, 14
    s_lshl_b32 s66, s67, 12
    s_add_u32 s44, s44, s66
    s_mul_i32 s45, s67, 196608
    s_lshl_b32 s66, s42, 7
    s_add_u32 s45, s45, s66
    s_lshl_b32 s66, s65, 6
    s_add_u32 s45, s45, s66
    s_mul_i32 s46, s67, 229376
    s_mul_i32 s66, s42, 7
    s_mul_i32 s47, s43, 3
    s_add_u32 s51, s66, s47
    s_lshl_b32 s47, s51, 6
    s_add_u32 s46, s46, s47
    s_and_b32 s101, s41, 1
    s_lshl_b32 s101, s101, 1
    s_and_b32 s66, s40, 1
    s_add_u32 s101, s101, s66
    s_mul_i32 s101, s101, 229376
    s_add_u32 s101, s101, s47
    v_mul_u32_u24 v18, 3584, v1
    s_lshl_b32 s47, s41, 2
    s_add_u32 s47, s47, s67
    s_lshl_b32 s66, s51, 1
    s_mul_i32 s51, s47, 112
    s_add_u32 s51, s51, s66
    s_add_u32 s51, s51, s65
    s_lshl_b32 s51, s51, 10
    s_add_u32 s51, s51, 0x1000000
    s_lshl_b32 s66, s42, 1
    s_add_u32 s66, s66, s65
    s_lshl_b32 s66, s66, 7
    s_add_u32 s66, s66, s47
    s_lshl_b32 s49, s66, 10
    s_add_u32 s50, s49, 0x400000
    s_mov_b32 s52, 0x3f803f80
    s_mov_b32 s53, 0x00003f80
    s_mov_b32 s54, 0x3f800000
    s_lshl_b32 s96, s40, 11
    s_lshl_b32 s95, s93, 16
    s_add_u32 s95, s95, s96
    s_lshl_b32 s97, s2, 7
    s_add_u32 s97, s97, 0xb00000
    s_lshl_b32 s66, s94, 3
    s_add_u32 s66, s66, s40
    s_lshl_b32 s99, s66, 5
    s_add_u32 s99, s99, s93
    s_lshl_b32 s99, s99, 10
    s_add_u32 s99, s99, 0x600000
    v_lshlrev_b32 v2, 4, v1
    v_and_b32 v26, 0x33, v1
    v_and_b32 v27, 4, v1
    v_lshl_or_b32 v26, v27, 1, v26
    v_and_b32 v27, 8, v1
    v_lshrrev_b32 v27, 1, v27
    v_or_b32 v26, v26, v27
    v_lshlrev_b32 v3, 4, v26
    v_bfe_u32 v26, v1, 4, 1
    v_lshlrev_b32 v26, 16, v26
    v_lshrrev_b32 v27, 5, v1
    v_lshl_add_u32 v26, v27, 8, v26
    v_and_b32 v27, 15, v1
    v_lshl_add_u32 v4, v27, 4, v26
    v_bfe_u32 v26, v1, 2, 2
    v_lshrrev_b32 v27, 5, v1
    v_lshl_add_u32 v26, v27, 3, v26
    v_lshlrev_b32 v26, 6, v26
    v_and_b32 v27, 3, v1
    v_lshl_add_u32 v26, v27, 3, v26
    v_bfe_u32 v27, v1, 4, 1
    s_lshl_b32 s66, s65, 14
    v_lshl_add_u32 v7, v27, 5, v26
    v_add_u32 v7, s66, v7
    v_lshl_add_u32 v28, v27, 14, v26
    v_xor_b32 v27, s65, v27
    v_lshl_add_u32 v8, v27, 5, v28
    v_xor_b32 v26, v24, v25
    s_and_b32 s65, s40, 1
    s_lshl_b32 s65, s65, 8
    s_lshr_b32 s66, s40, 1
    s_lshl_b32 s66, s66, 14
    s_add_u32 s65, s65, s66
    v_lshlrev_b32 v26, 4, v26
    v_add_u32 v26, s65, v26
    v_lshrrev_b32 v27, 1, v25
    v_lshl_add_u32 v26, v27, 10, v26
    v_and_b32 v27, 1, v25
    v_lshl_add_u32 v14, v27, 9, v26
    v_add_u32 v15, 65536, v14
    s_and_b32 s65, s40, 3
    s_lshl_b32 s65, s65, 14
    v_and_b32 v26, 31, v1
    v_lshrrev_b32 v27, 5, v1
    v_add_u32 v28, 0, v27
    v_xor_b32 v28, v26, v28
    v_lshlrev_b32 v28, 4, v28
    v_lshl_add_u32 v28, v27, 9, v28
    v_add_u32 v28, s65, v28
    v_add_u32 v10, 0, v28
    v_add_u32 v28, 2, v27
    v_xor_b32 v28, v26, v28
    v_lshlrev_b32 v28, 4, v28
    v_lshl_add_u32 v28, v27, 9, v28
    v_add_u32 v28, s65, v28
    v_add_u32 v11, 1024, v28
    v_add_u32 v28, 4, v27
    v_xor_b32 v28, v26, v28
    v_lshlrev_b32 v28, 4, v28
    v_lshl_add_u32 v28, v27, 9, v28
    v_add_u32 v28, s65, v28
    v_add_u32 v12, 2048, v28
    v_add_u32 v28, 6, v27
    v_xor_b32 v28, v26, v28
    v_lshlrev_b32 v28, 4, v28
    v_lshl_add_u32 v28, v27, 9, v28
    v_add_u32 v28, s65, v28
    v_add_u32 v13, 3072, v28
    v_mov_b32 v28, 0x40000000
    v_cmp_eq_u32 vcc, 0, v0
    s_nop 1
    v_cndmask_b32 v1, v28, 0, vcc
    s_mov_b32 s24, s6
    s_mov_b32 s25, s7
    s_mov_b32 s26, 0x180000
    s_mov_b32 s27, 0x20000
    s_mov_b32 s36, s70
    s_mov_b32 s37, s71
    s_mov_b32 s38, 0x1800000
    s_mov_b32 s39, 0x20000
    s_mov_b32 s10, s70
    s_mov_b32 s11, s71
    s_mov_b32 s70, 256
    s_mov_b32 s71, 0x20000
    s_cmp_ge_u32 s40, 4
    s_cselect_b32 s28, s14, s12
    s_cselect_b32 s29, s15, s13
    s_mov_b32 s30, 0x1c0000
    s_mov_b32 s31, 0x20000
    s_bitcmp1_b32 s41, 1
    s_cselect_b32 s32, s14, s12
    s_cselect_b32 s33, s15, s13
    s_mov_b32 s34, 0x1c0000
    s_mov_b32 s35, 0x20000
    s_waitcnt vmcnt(15)
    v_dot2_f32_bf16 v24, v64, s52, 0
    v_dot2_f32_bf16 v25, v65, s52, 0
    v_dot2_f32_bf16 v26, v66, s52, 0
    v_dot2_f32_bf16 v27, v67, s52, 0
    s_waitcnt vmcnt(14)
    v_dot2_f32_bf16 v24, v68, s52, v24
    v_dot2_f32_bf16 v25, v69, s52, v25
    v_dot2_f32_bf16 v26, v70, s52, v26
    v_dot2_f32_bf16 v27, v71, s52, v27
    s_waitcnt vmcnt(13)
    v_dot2_f32_bf16 v24, v72, s52, v24
    v_dot2_f32_bf16 v25, v73, s52, v25
    v_dot2_f32_bf16 v26, v74, s52, v26
    v_dot2_f32_bf16 v27, v75, s52, v27
    s_waitcnt vmcnt(12)
    v_dot2_f32_bf16 v24, v76, s52, v24
    v_dot2_f32_bf16 v25, v77, s52, v25
    v_dot2_f32_bf16 v26, v78, s52, v26
    v_dot2_f32_bf16 v27, v79, s52, v27
    s_waitcnt vmcnt(11)
    v_dot2_f32_bf16 v24, v80, s52, v24
    v_dot2_f32_bf16 v25, v81, s52, v25
    v_dot2_f32_bf16 v26, v82, s52, v26
    v_dot2_f32_bf16 v27, v83, s52, v27
    s_waitcnt vmcnt(10)
    v_dot2_f32_bf16 v24, v84, s52, v24
    v_dot2_f32_bf16 v25, v85, s52, v25
    v_dot2_f32_bf16 v26, v86, s52, v26
    v_dot2_f32_bf16 v27, v87, s52, v27
    s_waitcnt vmcnt(9)
    v_dot2_f32_bf16 v24, v88, s52, v24
    v_dot2_f32_bf16 v25, v89, s52, v25
    v_dot2_f32_bf16 v26, v90, s52, v26
    v_dot2_f32_bf16 v27, v91, s52, v27
    s_waitcnt vmcnt(8)
    v_dot2_f32_bf16 v24, v92, s52, v24
    v_dot2_f32_bf16 v25, v93, s52, v25
    v_dot2_f32_bf16 v26, v94, s52, v26
    v_dot2_f32_bf16 v27, v95, s52, v27
    s_nop 0
    v_add_f32 v24, v24, v25
    s_nop 0
    v_add_f32 v26, v26, v27
    v_add_f32 v24, v24, v26
    s_nop 1
    v_add_f32_dpp v24, v24, v24 quad_perm:[1,0,3,2] row_mask:0xf bank_mask:0xf
    s_nop 1
    v_add_f32_dpp v24, v24, v24 quad_perm:[2,3,0,1] row_mask:0xf bank_mask:0xf
    s_nop 1
    v_add_f32_dpp v24, v24, v24 row_half_mirror row_mask:0xf bank_mask:0xf
    v_mul_f32 v20, 0xbb000000, v24
    v_dot2_f32_bf16 v128, v64, s53, v20
    v_dot2_f32_bf16 v129, v64, s54, v20
    v_dot2_f32_bf16 v130, v65, s53, v20
    v_dot2_f32_bf16 v131, v65, s54, v20
    v_dot2_f32_bf16 v132, v66, s53, v20
    v_dot2_f32_bf16 v133, v66, s54, v20
    v_dot2_f32_bf16 v134, v67, s53, v20
    v_dot2_f32_bf16 v135, v67, s54, v20
    v_dot2_f32_bf16 v136, v68, s53, v20
    v_dot2_f32_bf16 v137, v68, s54, v20
    v_dot2_f32_bf16 v138, v69, s53, v20
    v_dot2_f32_bf16 v139, v69, s54, v20
    v_dot2_f32_bf16 v140, v70, s53, v20
    v_dot2_f32_bf16 v141, v70, s54, v20
    v_dot2_f32_bf16 v142, v71, s53, v20
    v_dot2_f32_bf16 v143, v71, s54, v20
    v_cvt_pk_bf16_f32 v64, v128, v129
    v_cvt_pk_bf16_f32 v65, v130, v131
    v_cvt_pk_bf16_f32 v66, v132, v133
    v_cvt_pk_bf16_f32 v67, v134, v135
    v_cvt_pk_bf16_f32 v68, v136, v137
    v_cvt_pk_bf16_f32 v69, v138, v139
    v_cvt_pk_bf16_f32 v70, v140, v141
    v_cvt_pk_bf16_f32 v71, v142, v143
    v_dot2_f32_bf16 v24, v64, v64, 0
    v_dot2_f32_bf16 v25, v65, v65, 0
    v_dot2_f32_bf16 v26, v66, v66, 0
    v_dot2_f32_bf16 v27, v67, v67, 0
    v_dot2_f32_bf16 v24, v68, v68, v24
    v_dot2_f32_bf16 v25, v69, v69, v25
    v_dot2_f32_bf16 v26, v70, v70, v26
    v_dot2_f32_bf16 v27, v71, v71, v27
    ds_write_b128 v14, v[64:67] offset:0
    ds_write_b128 v14, v[68:71] offset:4096
    v_dot2_f32_bf16 v128, v72, s53, v20
    v_dot2_f32_bf16 v129, v72, s54, v20
    v_dot2_f32_bf16 v130, v73, s53, v20
    v_dot2_f32_bf16 v131, v73, s54, v20
    v_dot2_f32_bf16 v132, v74, s53, v20
    v_dot2_f32_bf16 v133, v74, s54, v20
    v_dot2_f32_bf16 v134, v75, s53, v20
    v_dot2_f32_bf16 v135, v75, s54, v20
    v_dot2_f32_bf16 v136, v76, s53, v20
    v_dot2_f32_bf16 v137, v76, s54, v20
    v_dot2_f32_bf16 v138, v77, s53, v20
    v_dot2_f32_bf16 v139, v77, s54, v20
    v_dot2_f32_bf16 v140, v78, s53, v20
    v_dot2_f32_bf16 v141, v78, s54, v20
    v_dot2_f32_bf16 v142, v79, s53, v20
    v_dot2_f32_bf16 v143, v79, s54, v20
    v_cvt_pk_bf16_f32 v72, v128, v129
    v_cvt_pk_bf16_f32 v73, v130, v131
    v_cvt_pk_bf16_f32 v74, v132, v133
    v_cvt_pk_bf16_f32 v75, v134, v135
    v_cvt_pk_bf16_f32 v76, v136, v137
    v_cvt_pk_bf16_f32 v77, v138, v139
    v_cvt_pk_bf16_f32 v78, v140, v141
    v_cvt_pk_bf16_f32 v79, v142, v143
    v_dot2_f32_bf16 v24, v72, v72, v24
    v_dot2_f32_bf16 v25, v73, v73, v25
    v_dot2_f32_bf16 v26, v74, v74, v26
    v_dot2_f32_bf16 v27, v75, v75, v27
    v_dot2_f32_bf16 v24, v76, v76, v24
    v_dot2_f32_bf16 v25, v77, v77, v25
    v_dot2_f32_bf16 v26, v78, v78, v26
    v_dot2_f32_bf16 v27, v79, v79, v27
    ds_write_b128 v14, v[72:75] offset:8192
    ds_write_b128 v14, v[76:79] offset:12288
    v_dot2_f32_bf16 v128, v80, s53, v20
    v_dot2_f32_bf16 v129, v80, s54, v20
    v_dot2_f32_bf16 v130, v81, s53, v20
    v_dot2_f32_bf16 v131, v81, s54, v20
    v_dot2_f32_bf16 v132, v82, s53, v20
    v_dot2_f32_bf16 v133, v82, s54, v20
    v_dot2_f32_bf16 v134, v83, s53, v20
    v_dot2_f32_bf16 v135, v83, s54, v20
    v_dot2_f32_bf16 v136, v84, s53, v20
    v_dot2_f32_bf16 v137, v84, s54, v20
    v_dot2_f32_bf16 v138, v85, s53, v20
    v_dot2_f32_bf16 v139, v85, s54, v20
    v_dot2_f32_bf16 v140, v86, s53, v20
    v_dot2_f32_bf16 v141, v86, s54, v20
    v_dot2_f32_bf16 v142, v87, s53, v20
    v_dot2_f32_bf16 v143, v87, s54, v20
    v_cvt_pk_bf16_f32 v80, v128, v129
    v_cvt_pk_bf16_f32 v81, v130, v131
    v_cvt_pk_bf16_f32 v82, v132, v133
    v_cvt_pk_bf16_f32 v83, v134, v135
    v_cvt_pk_bf16_f32 v84, v136, v137
    v_cvt_pk_bf16_f32 v85, v138, v139
    v_cvt_pk_bf16_f32 v86, v140, v141
    v_cvt_pk_bf16_f32 v87, v142, v143
    v_dot2_f32_bf16 v24, v80, v80, v24
    v_dot2_f32_bf16 v25, v81, v81, v25
    v_dot2_f32_bf16 v26, v82, v82, v26
    v_dot2_f32_bf16 v27, v83, v83, v27
    v_dot2_f32_bf16 v24, v84, v84, v24
    v_dot2_f32_bf16 v25, v85, v85, v25
    v_dot2_f32_bf16 v26, v86, v86, v26
    v_dot2_f32_bf16 v27, v87, v87, v27
    ds_write_b128 v15, v[80:83] offset:0
    ds_write_b128 v15, v[84:87] offset:4096
    v_dot2_f32_bf16 v128, v88, s53, v20
    v_dot2_f32_bf16 v129, v88, s54, v20
    v_dot2_f32_bf16 v130, v89, s53, v20
    v_dot2_f32_bf16 v131, v89, s54, v20
    v_dot2_f32_bf16 v132, v90, s53, v20
    v_dot2_f32_bf16 v133, v90, s54, v20
    v_dot2_f32_bf16 v134, v91, s53, v20
    v_dot2_f32_bf16 v135, v91, s54, v20
    v_dot2_f32_bf16 v136, v92, s53, v20
    v_dot2_f32_bf16 v137, v92, s54, v20
    v_dot2_f32_bf16 v138, v93, s53, v20
    v_dot2_f32_bf16 v139, v93, s54, v20
    v_dot2_f32_bf16 v140, v94, s53, v20
    v_dot2_f32_bf16 v141, v94, s54, v20
    v_dot2_f32_bf16 v142, v95, s53, v20
    v_dot2_f32_bf16 v143, v95, s54, v20
    v_cvt_pk_bf16_f32 v88, v128, v129
    v_cvt_pk_bf16_f32 v89, v130, v131
    v_cvt_pk_bf16_f32 v90, v132, v133
    v_cvt_pk_bf16_f32 v91, v134, v135
    v_cvt_pk_bf16_f32 v92, v136, v137
    v_cvt_pk_bf16_f32 v93, v138, v139
    v_cvt_pk_bf16_f32 v94, v140, v141
    v_cvt_pk_bf16_f32 v95, v142, v143
    v_dot2_f32_bf16 v24, v88, v88, v24
    v_dot2_f32_bf16 v25, v89, v89, v25
    v_dot2_f32_bf16 v26, v90, v90, v26
    v_dot2_f32_bf16 v27, v91, v91, v27
    v_dot2_f32_bf16 v24, v92, v92, v24
    v_dot2_f32_bf16 v25, v93, v93, v25
    v_dot2_f32_bf16 v26, v94, v94, v26
    v_dot2_f32_bf16 v27, v95, v95, v27
    ds_write_b128 v15, v[88:91] offset:8192
    ds_write_b128 v15, v[92:95] offset:12288
    v_add_f32 v24, v24, v25
    v_add_f32 v26, v26, v27
    v_add_f32 v24, v24, v26
    s_nop 1
    v_add_f32_dpp v24, v24, v24 quad_perm:[1,0,3,2] row_mask:0xf bank_mask:0xf
    s_nop 1
    v_add_f32_dpp v24, v24, v24 quad_perm:[2,3,0,1] row_mask:0xf bank_mask:0xf
    s_nop 1
    v_add_f32_dpp v24, v24, v24 row_half_mirror row_mask:0xf bank_mask:0xf
    v_mul_f32 v24, 0x3b000000, v24
    v_add_f32 v24, 0x3727c5ac, v24
    v_rsq_f32 v22, v24
    s_waitcnt vmcnt(7)
    v_dot2_f32_bf16 v28, v96, s52, 0
    v_dot2_f32_bf16 v29, v97, s52, 0
    v_dot2_f32_bf16 v30, v98, s52, 0
    v_dot2_f32_bf16 v31, v99, s52, 0
    s_waitcnt vmcnt(6)
    v_dot2_f32_bf16 v28, v100, s52, v28
    v_dot2_f32_bf16 v29, v101, s52, v29
    v_dot2_f32_bf16 v30, v102, s52, v30
    v_dot2_f32_bf16 v31, v103, s52, v31
    s_waitcnt vmcnt(5)
    v_dot2_f32_bf16 v28, v104, s52, v28
    v_dot2_f32_bf16 v29, v105, s52, v29
    v_dot2_f32_bf16 v30, v106, s52, v30
    v_dot2_f32_bf16 v31, v107, s52, v31
    s_waitcnt vmcnt(4)
    v_dot2_f32_bf16 v28, v108, s52, v28
    v_dot2_f32_bf16 v29, v109, s52, v29
    v_dot2_f32_bf16 v30, v110, s52, v30
    v_dot2_f32_bf16 v31, v111, s52, v31
    s_waitcnt vmcnt(3)
    v_dot2_f32_bf16 v28, v112, s52, v28
    v_dot2_f32_bf16 v29, v113, s52, v29
    v_dot2_f32_bf16 v30, v114, s52, v30
    v_dot2_f32_bf16 v31, v115, s52, v31
    s_waitcnt vmcnt(2)
    v_dot2_f32_bf16 v28, v116, s52, v28
    v_dot2_f32_bf16 v29, v117, s52, v29
    v_dot2_f32_bf16 v30, v118, s52, v30
    v_dot2_f32_bf16 v31, v119, s52, v31
    s_waitcnt vmcnt(1)
    v_dot2_f32_bf16 v28, v120, s52, v28
    v_dot2_f32_bf16 v29, v121, s52, v29
    v_dot2_f32_bf16 v30, v122, s52, v30
    v_dot2_f32_bf16 v31, v123, s52, v31
    s_waitcnt vmcnt(0)
    v_dot2_f32_bf16 v28, v124, s52, v28
    v_dot2_f32_bf16 v29, v125, s52, v29
    v_dot2_f32_bf16 v30, v126, s52, v30
    v_dot2_f32_bf16 v31, v127, s52, v31
    s_nop 0
    v_add_f32 v28, v28, v29
    s_nop 0
    v_add_f32 v30, v30, v31
    v_add_f32 v28, v28, v30
    s_nop 1
    v_add_f32_dpp v28, v28, v28 quad_perm:[1,0,3,2] row_mask:0xf bank_mask:0xf
    s_nop 1
    v_add_f32_dpp v28, v28, v28 quad_perm:[2,3,0,1] row_mask:0xf bank_mask:0xf
    s_nop 1
    v_add_f32_dpp v28, v28, v28 row_half_mirror row_mask:0xf bank_mask:0xf
    v_mul_f32 v21, 0xbb000000, v28
    s_lshl_b32 s66, s43, 11
    s_add_u32 s66, s66, s45
    s_cmp_ge_u32 s40, 4
    s_cbranch_scc1 L_nou0
    s_add_u32 m0, s44, 131072
    s_add_u32 s47, s66, 0
    buffer_load_dwordx4 v5, s[24:27], s47 offen lds
    s_add_u32 m0, s44, 132096
    s_add_u32 s48, s66, 49152
    buffer_load_dwordx4 v5, s[24:27], s48 offen lds
    s_add_u32 m0, s44, 133120
    s_add_u32 s47, s66, 98304
    buffer_load_dwordx4 v5, s[24:27], s47 offen lds
    s_add_u32 m0, s44, 134144
    s_add_u32 s48, s66, 147456
    buffer_load_dwordx4 v5, s[24:27], s48 offen lds
    s_add_u32 m0, s44, 147456
    s_add_u32 s47, s66, 64
    buffer_load_dwordx4 v5, s[24:27], s47 offen lds
    s_add_u32 m0, s44, 148480
    s_add_u32 s48, s66, 49216
    buffer_load_dwordx4 v5, s[24:27], s48 offen lds
    s_add_u32 m0, s44, 149504
    s_add_u32 s47, s66, 98368
    buffer_load_dwordx4 v5, s[24:27], s47 offen lds
    s_add_u32 m0, s44, 150528
    s_add_u32 s48, s66, 147520
    buffer_load_dwordx4 v5, s[24:27], s48 offen lds
L_nou0:
    s_and_b32 s65, s41, 1
    s_lshl_b32 s65, s65, 1
    s_and_b32 s66, s40, 1
    s_add_u32 s65, s65, s66
    s_lshl_b32 s65, s65, 6
    s_add_u32 s65, s65, 256
    s_mul_i32 s65, s65, 3072
    s_lshl_b32 s66, s43, 11
    s_add_u32 s65, s65, s66
    s_lshl_b32 s66, s42, 7
    s_add_u32 s65, s65, s66
    s_bfe_u32 s66, s41, 0x10001
    s_lshl_b32 s66, s66, 6
    s_add_u32 s65, s65, s66
    s_cmp_lt_u32 s40, 2
    s_cselect_b32 s65, s65, 0x40000000
    v_bfe_u32 v18, v2, 4, 6
    v_mul_u32_u24 v18, 3072, v18
    buffer_load_dword v16, v18, s[24:27], s65 offen
    v_dot2_f32_bf16 v128, v96, s53, v21
    v_dot2_f32_bf16 v129, v96, s54, v21
    v_dot2_f32_bf16 v130, v97, s53, v21
    v_dot2_f32_bf16 v131, v97, s54, v21
    v_dot2_f32_bf16 v132, v98, s53, v21
    v_dot2_f32_bf16 v133, v98, s54, v21
    v_dot2_f32_bf16 v134, v99, s53, v21
    v_dot2_f32_bf16 v135, v99, s54, v21
    v_dot2_f32_bf16 v136, v100, s53, v21
    v_dot2_f32_bf16 v137, v100, s54, v21
    v_dot2_f32_bf16 v138, v101, s53, v21
    v_dot2_f32_bf16 v139, v101, s54, v21
    v_dot2_f32_bf16 v140, v102, s53, v21
    v_dot2_f32_bf16 v141, v102, s54, v21
    v_dot2_f32_bf16 v142, v103, s53, v21
    v_dot2_f32_bf16 v143, v103, s54, v21
    v_cvt_pk_bf16_f32 v96, v128, v129
    v_cvt_pk_bf16_f32 v97, v130, v131
    v_cvt_pk_bf16_f32 v98, v132, v133
    v_cvt_pk_bf16_f32 v99, v134, v135
    v_cvt_pk_bf16_f32 v100, v136, v137
    v_cvt_pk_bf16_f32 v101, v138, v139
    v_cvt_pk_bf16_f32 v102, v140, v141
    v_cvt_pk_bf16_f32 v103, v142, v143
    v_dot2_f32_bf16 v28, v96, v96, 0
    v_dot2_f32_bf16 v29, v97, v97, 0
    v_dot2_f32_bf16 v30, v98, v98, 0
    v_dot2_f32_bf16 v31, v99, v99, 0
    v_dot2_f32_bf16 v28, v100, v100, v28
    v_dot2_f32_bf16 v29, v101, v101, v29
    v_dot2_f32_bf16 v30, v102, v102, v30
    v_dot2_f32_bf16 v31, v103, v103, v31
    ds_write_b128 v14, v[96:99] offset:128
    ds_write_b128 v14, v[100:103] offset:4224
    v_dot2_f32_bf16 v128, v104, s53, v21
    v_dot2_f32_bf16 v129, v104, s54, v21
    v_dot2_f32_bf16 v130, v105, s53, v21
    v_dot2_f32_bf16 v131, v105, s54, v21
    v_dot2_f32_bf16 v132, v106, s53, v21
    v_dot2_f32_bf16 v133, v106, s54, v21
    v_dot2_f32_bf16 v134, v107, s53, v21
    v_dot2_f32_bf16 v135, v107, s54, v21
    v_dot2_f32_bf16 v136, v108, s53, v21
    v_dot2_f32_bf16 v137, v108, s54, v21
    v_dot2_f32_bf16 v138, v109, s53, v21
    v_dot2_f32_bf16 v139, v109, s54, v21
    v_dot2_f32_bf16 v140, v110, s53, v21
    v_dot2_f32_bf16 v141, v110, s54, v21
    v_dot2_f32_bf16 v142, v111, s53, v21
    v_dot2_f32_bf16 v143, v111, s54, v21
    v_cvt_pk_bf16_f32 v104, v128, v129
    v_cvt_pk_bf16_f32 v105, v130, v131
    v_cvt_pk_bf16_f32 v106, v132, v133
    v_cvt_pk_bf16_f32 v107, v134, v135
    v_cvt_pk_bf16_f32 v108, v136, v137
    v_cvt_pk_bf16_f32 v109, v138, v139
    v_cvt_pk_bf16_f32 v110, v140, v141
    v_cvt_pk_bf16_f32 v111, v142, v143
    v_dot2_f32_bf16 v28, v104, v104, v28
    v_dot2_f32_bf16 v29, v105, v105, v29
    v_dot2_f32_bf16 v30, v106, v106, v30
    v_dot2_f32_bf16 v31, v107, v107, v31
    v_dot2_f32_bf16 v28, v108, v108, v28
    v_dot2_f32_bf16 v29, v109, v109, v29
    v_dot2_f32_bf16 v30, v110, v110, v30
    v_dot2_f32_bf16 v31, v111, v111, v31
    ds_write_b128 v14, v[104:107] offset:8320
    ds_write_b128 v14, v[108:111] offset:12416
    v_dot2_f32_bf16 v128, v112, s53, v21
    v_dot2_f32_bf16 v129, v112, s54, v21
    v_dot2_f32_bf16 v130, v113, s53, v21
    v_dot2_f32_bf16 v131, v113, s54, v21
    v_dot2_f32_bf16 v132, v114, s53, v21
    v_dot2_f32_bf16 v133, v114, s54, v21
    v_dot2_f32_bf16 v134, v115, s53, v21
    v_dot2_f32_bf16 v135, v115, s54, v21
    v_dot2_f32_bf16 v136, v116, s53, v21
    v_dot2_f32_bf16 v137, v116, s54, v21
    v_dot2_f32_bf16 v138, v117, s53, v21
    v_dot2_f32_bf16 v139, v117, s54, v21
    v_dot2_f32_bf16 v140, v118, s53, v21
    v_dot2_f32_bf16 v141, v118, s54, v21
    v_dot2_f32_bf16 v142, v119, s53, v21
    v_dot2_f32_bf16 v143, v119, s54, v21
    v_cvt_pk_bf16_f32 v112, v128, v129
    v_cvt_pk_bf16_f32 v113, v130, v131
    v_cvt_pk_bf16_f32 v114, v132, v133
    v_cvt_pk_bf16_f32 v115, v134, v135
    v_cvt_pk_bf16_f32 v116, v136, v137
    v_cvt_pk_bf16_f32 v117, v138, v139
    v_cvt_pk_bf16_f32 v118, v140, v141
    v_cvt_pk_bf16_f32 v119, v142, v143
    v_dot2_f32_bf16 v28, v112, v112, v28
    v_dot2_f32_bf16 v29, v113, v113, v29
    v_dot2_f32_bf16 v30, v114, v114, v30
    v_dot2_f32_bf16 v31, v115, v115, v31
    v_dot2_f32_bf16 v28, v116, v116, v28
    v_dot2_f32_bf16 v29, v117, v117, v29
    v_dot2_f32_bf16 v30, v118, v118, v30
    v_dot2_f32_bf16 v31, v119, v119, v31
    ds_write_b128 v15, v[112:115] offset:128
    ds_write_b128 v15, v[116:119] offset:4224
    s_waitcnt lgkmcnt(8)
    v_dot2_f32_bf16 v128, v120, s53, v21
    v_dot2_f32_bf16 v129, v120, s54, v21
    v_dot2_f32_bf16 v130, v121, s53, v21
    v_dot2_f32_bf16 v131, v121, s54, v21
    v_dot2_f32_bf16 v132, v122, s53, v21
    v_dot2_f32_bf16 v133, v122, s54, v21
    v_dot2_f32_bf16 v134, v123, s53, v21
    v_dot2_f32_bf16 v135, v123, s54, v21
    v_dot2_f32_bf16 v136, v124, s53, v21
    v_dot2_f32_bf16 v137, v124, s54, v21
    v_dot2_f32_bf16 v138, v125, s53, v21
    v_dot2_f32_bf16 v139, v125, s54, v21
    v_dot2_f32_bf16 v140, v126, s53, v21
    v_dot2_f32_bf16 v141, v126, s54, v21
    v_dot2_f32_bf16 v142, v127, s53, v21
    v_dot2_f32_bf16 v143, v127, s54, v21
    v_cvt_pk_bf16_f32 v120, v128, v129
    v_cvt_pk_bf16_f32 v121, v130, v131
    v_cvt_pk_bf16_f32 v122, v132, v133
    v_cvt_pk_bf16_f32 v123, v134, v135
    v_cvt_pk_bf16_f32 v124, v136, v137
    v_cvt_pk_bf16_f32 v125, v138, v139
    v_cvt_pk_bf16_f32 v126, v140, v141
    v_cvt_pk_bf16_f32 v127, v142, v143
    v_dot2_f32_bf16 v28, v120, v120, v28
    v_dot2_f32_bf16 v29, v121, v121, v29
    v_dot2_f32_bf16 v30, v122, v122, v30
    v_dot2_f32_bf16 v31, v123, v123, v31
    v_dot2_f32_bf16 v28, v124, v124, v28
    v_dot2_f32_bf16 v29, v125, v125, v29
    v_dot2_f32_bf16 v30, v126, v126, v30
    v_dot2_f32_bf16 v31, v127, v127, v31
    ds_write_b128 v15, v[120:123] offset:8320
    ds_write_b128 v15, v[124:127] offset:12416
    v_add_f32 v28, v28, v29
    v_add_f32 v30, v30, v31
    v_add_f32 v28, v28, v30
    s_nop 1
    v_add_f32_dpp v28, v28, v28 quad_perm:[1,0,3,2] row_mask:0xf bank_mask:0xf
    s_nop 1
    v_add_f32_dpp v28, v28, v28 quad_perm:[2,3,0,1] row_mask:0xf bank_mask:0xf
    s_nop 1
    v_add_f32_dpp v28, v28, v28 row_half_mirror row_mask:0xf bank_mask:0xf
    v_mul_f32 v28, 0x3b000000, v28
    v_add_f32 v28, 0x3727c5ac, v28
    v_rsq_f32 v23, v28
    s_lshl_b32 s65, s2, 9
    s_lshl_b32 s66, s40, 6
    s_add_u32 s65, s65, s66
    s_add_u32 s65, s65, 0xc00000
    v_lshrrev_b32 v21, 7, v2
    v_lshlrev_b32 v21, 2, v21
    buffer_store_dword v22, v21, s[36:39], s65 offen
    buffer_store_dword v23, v21, s[36:39], s65 offen offset:32
    v_mov_b32 v31, v1
    s_waitcnt lgkmcnt(0)
    s_barrier
    ds_read_b128 v[128:131], v10 offset:0
    ds_read_b128 v[132:135], v11 offset:0
    ds_read_b128 v[136:139], v12 offset:0
    ds_read_b128 v[140:143], v13 offset:0
    ds_read_b128 v[144:147], v10 offset:4096
    ds_read_b128 v[148:151], v11 offset:4096
    ds_read_b128 v[152:155], v12 offset:4096
    ds_read_b128 v[156:159], v13 offset:4096
    ds_read_b128 v[160:163], v10 offset:8192
    ds_read_b128 v[164:167], v11 offset:8192
    ds_read_b128 v[168:171], v12 offset:8192
    ds_read_b128 v[172:175], v13 offset:8192
    ds_read_b128 v[176:179], v10 offset:12288
    s_waitcnt lgkmcnt(8)
    ds_read_b128 v[180:183], v11 offset:12288
    ds_read_b128 v[184:187], v12 offset:12288
    ds_read_b128 v[188:191], v13 offset:12288
    v_add_u32 v10, 65536, v10
    v_add_u32 v11, 65536, v11
    v_add_u32 v12, 65536, v12
    v_add_u32 v13, 65536, v13
    s_waitcnt lgkmcnt(0)
    s_waitcnt vmcnt(3)
    s_barrier
    s_cmp_eq_u32 s43, 1
    s_cbranch_scc1 L_typeA
L_B:
    v_add_u32 v9, 131072, v7
    ds_read_b64_tr_b16 v[64:65], v9 offset:0
    ds_read_b64_tr_b16 v[66:67], v9 offset:256
    ds_read_b64_tr_b16 v[68:69], v9 offset:1024
    ds_read_b64_tr_b16 v[70:71], v9 offset:1280
    ds_read_b64_tr_b16 v[72:73], v9 offset:2048
    ds_read_b64_tr_b16 v[74:75], v9 offset:2304
    ds_read_b64_tr_b16 v[76:77], v9 offset:3072
    ds_read_b64_tr_b16 v[78:79], v9 offset:3328
    s_waitcnt lgkmcnt(6)
    v_mfma_f32_32x32x16_bf16 v[32:47], v[64:67], v[128:131], 0
    s_add_u32 m0, s44, 0
    s_add_u32 s47, s45, 786432
    buffer_load_dwordx4 v5, s[24:27], s47 offen lds
    ds_read_b128 v[192:195], v10 offset:0
    ds_read_b64_tr_b16 v[64:65], v9 offset:4096
    ds_read_b64_tr_b16 v[66:67], v9 offset:4352
    s_waitcnt lgkmcnt(7)
    v_mfma_f32_32x32x16_bf16 v[32:47], v[68:71], v[132:135], v[32:47]
    s_add_u32 m0, s44, 1024
    s_add_u32 s48, s45, 835584
    buffer_load_dwordx4 v5, s[24:27], s48 offen lds
    ds_read_b128 v[196:199], v11 offset:0
    ds_read_b64_tr_b16 v[68:69], v9 offset:5120
    ds_read_b64_tr_b16 v[70:71], v9 offset:5376
    s_waitcnt lgkmcnt(8)
    v_mfma_f32_32x32x16_bf16 v[32:47], v[72:75], v[136:139], v[32:47]
    s_add_u32 m0, s44, 2048
    s_add_u32 s47, s45, 884736
    buffer_load_dwordx4 v5, s[24:27], s47 offen lds
    ds_read_b128 v[200:203], v12 offset:0
    ds_read_b64_tr_b16 v[72:73], v9 offset:6144
    ds_read_b64_tr_b16 v[74:75], v9 offset:6400
    s_waitcnt lgkmcnt(9)
    v_mfma_f32_32x32x16_bf16 v[32:47], v[76:79], v[140:143], v[32:47]
    s_add_u32 m0, s44, 3072
    s_add_u32 s48, s45, 933888
    buffer_load_dwordx4 v5, s[24:27], s48 offen lds
    ds_read_b128 v[204:207], v13 offset:0
    ds_read_b64_tr_b16 v[76:77], v9 offset:7168
    ds_read_b64_tr_b16 v[78:79], v9 offset:7424
    s_waitcnt lgkmcnt(9)
    v_mfma_f32_32x32x16_bf16 v[32:47], v[64:67], v[144:147], v[32:47]
    ds_read_b128 v[208:211], v10 offset:4096
    ds_read_b128 v[212:215], v11 offset:4096
    ds_read_b64_tr_b16 v[64:65], v9 offset:8192
    ds_read_b64_tr_b16 v[66:67], v9 offset:8448
    s_waitcnt lgkmcnt(10)
    v_mfma_f32_32x32x16_bf16 v[32:47], v[68:71], v[148:151], v[32:47]
    ds_read_b128 v[216:219], v12 offset:4096
    ds_read_b64_tr_b16 v[68:69], v9 offset:9216
    ds_read_b64_tr_b16 v[70:71], v9 offset:9472
    s_waitcnt lgkmcnt(10)
    v_mfma_f32_32x32x16_bf16 v[32:47], v[72:75], v[152:155], v[32:47]
    s_add_u32 m0, s44, 32768
    s_add_u32 s47, s45, 1024
    buffer_load_dwordx4 v5, s[24:27], s47 offen lds
    ds_read_b128 v[220:223], v13 offset:4096
    ds_read_b64_tr_b16 v[72:73], v9 offset:10240
    ds_read_b64_tr_b16 v[74:75], v9 offset:10496
    s_waitcnt lgkmcnt(10)
    v_mfma_f32_32x32x16_bf16 v[32:47], v[76:79], v[156:159], v[32:47]
    ds_read_b128 v[224:227], v10 offset:8192
    ds_read_b64_tr_b16 v[76:77], v9 offset:11264
    ds_read_b64_tr_b16 v[78:79], v9 offset:11520
    s_waitcnt lgkmcnt(9)
    v_mfma_f32_32x32x16_bf16 v[32:47], v[64:67], v[160:163], v[32:47]
    s_add_u32 m0, s44, 33792
    s_add_u32 s48, s45, 50176
    buffer_load_dwordx4 v5, s[24:27], s48 offen lds
    ds_read_b128 v[228:231], v11 offset:8192
    ds_read_b128 v[232:235], v12 offset:8192
    ds_read_b64_tr_b16 v[64:65], v9 offset:12288
    ds_read_b64_tr_b16 v[66:67], v9 offset:12544
    s_waitcnt lgkmcnt(10)
    v_mfma_f32_32x32x16_bf16 v[32:47], v[68:71], v[164:167], v[32:47]
    ds_read_b128 v[236:239], v13 offset:8192
    ds_read_b64_tr_b16 v[68:69], v9 offset:13312
    ds_read_b64_tr_b16 v[70:71], v9 offset:13568
    s_waitcnt lgkmcnt(10)
    v_mfma_f32_32x32x16_bf16 v[32:47], v[72:75], v[168:171], v[32:47]
    s_add_u32 m0, s44, 34816
    s_add_u32 s47, s45, 99328
    buffer_load_dwordx4 v5, s[24:27], s47 offen lds
    ds_read_b128 v[240:243], v10 offset:12288
    ds_read_b64_tr_b16 v[72:73], v9 offset:14336
    ds_read_b64_tr_b16 v[74:75], v9 offset:14592
    s_waitcnt lgkmcnt(10)
    v_mfma_f32_32x32x16_bf16 v[32:47], v[76:79], v[172:175], v[32:47]
    ds_read_b128 v[244:247], v11 offset:12288
    ds_read_b64_tr_b16 v[76:77], v9 offset:15360
    ds_read_b64_tr_b16 v[78:79], v9 offset:15616
    s_waitcnt lgkmcnt(9)
    v_mfma_f32_32x32x16_bf16 v[32:47], v[64:67], v[176:179], v[32:47]
    s_add_u32 m0, s44, 35840
    s_add_u32 s48, s45, 148480
    buffer_load_dwordx4 v5, s[24:27], s48 offen lds
    ds_read_b128 v[248:251], v12 offset:12288
    ds_read_b128 v[252:255], v13 offset:12288
    s_waitcnt vmcnt(4)
    s_waitcnt lgkmcnt(0)
    s_barrier
    v_add_u32 v9, 0, v7
    s_lshl_b32 s65, s2, 9
    s_and_b32 s66, s40, 3
    s_lshl_b32 s66, s66, 7
    s_add_u32 s65, s65, s66
    s_add_u32 s65, s65, 0xc00000
    v_bfe_u32 v26, v2, 4, 5
    v_lshlrev_b32 v26, 2, v26
    buffer_load_dword v16, v26, s[36:39], s65 offen
    ds_read_b64_tr_b16 v[64:65], v9 offset:0
    ds_read_b64_tr_b16 v[66:67], v9 offset:256
    v_mfma_f32_32x32x16_bf16 v[32:47], v[68:71], v[180:183], v[32:47]
    v_mov_b32 v28, 0
    buffer_store_dword v28, v31, s[36:39], s97 offen sc1
    v_mov_b32 v24, -1
    v_mov_b32 v25, -1
    v_mov_b32 v26, -1
    v_mov_b32 v27, -1
    buffer_store_dwordx4 v[24:27], v2, s[36:39], s99 offen sc1
    ds_read_b64_tr_b16 v[68:69], v9 offset:1024
    ds_read_b64_tr_b16 v[70:71], v9 offset:1280
    v_mfma_f32_32x32x16_bf16 v[32:47], v[72:75], v[184:187], v[32:47]
    ds_read_b64_tr_b16 v[72:73], v9 offset:2048
    ds_read_b64_tr_b16 v[74:75], v9 offset:2304
    v_mfma_f32_32x32x16_bf16 v[32:47], v[76:79], v[188:191], v[32:47]
    ds_read_b64_tr_b16 v[76:77], v9 offset:3072
    ds_read_b64_tr_b16 v[78:79], v9 offset:3328
    s_waitcnt lgkmcnt(6)
    v_mfma_f32_32x32x16_bf16 v[32:47], v[64:67], v[192:195], v[32:47]
    s_add_u32 m0, s44, 65536
    s_add_u32 s47, s45, 787456
    buffer_load_dwordx4 v5, s[24:27], s47 offen lds
    ds_read_b64_tr_b16 v[64:65], v9 offset:4096
    ds_read_b64_tr_b16 v[66:67], v9 offset:4352
    s_waitcnt lgkmcnt(6)
    v_mfma_f32_32x32x16_bf16 v[32:47], v[68:71], v[196:199], v[32:47]
    ds_read_b64_tr_b16 v[68:69], v9 offset:5120
    ds_read_b64_tr_b16 v[70:71], v9 offset:5376
    s_waitcnt lgkmcnt(6)
    v_mfma_f32_32x32x16_bf16 v[32:47], v[72:75], v[200:203], v[32:47]
    ds_read_b64_tr_b16 v[72:73], v9 offset:6144
    ds_read_b64_tr_b16 v[74:75], v9 offset:6400
    s_waitcnt lgkmcnt(6)
    v_mfma_f32_32x32x16_bf16 v[32:47], v[76:79], v[204:207], v[32:47]
    ds_read_b64_tr_b16 v[76:77], v9 offset:7168
    ds_read_b64_tr_b16 v[78:79], v9 offset:7424
    s_waitcnt lgkmcnt(6)
    v_mfma_f32_32x32x16_bf16 v[32:47], v[64:67], v[208:211], v[32:47]
    s_add_u32 m0, s44, 66560
    s_add_u32 s48, s45, 836608
    buffer_load_dwordx4 v5, s[24:27], s48 offen lds
    ds_read_b64_tr_b16 v[64:65], v9 offset:8192
    ds_read_b64_tr_b16 v[66:67], v9 offset:8448
    s_waitcnt lgkmcnt(6)
    v_mfma_f32_32x32x16_bf16 v[32:47], v[68:71], v[212:215], v[32:47]
    ds_read_b64_tr_b16 v[68:69], v9 offset:9216
    ds_read_b64_tr_b16 v[70:71], v9 offset:9472
    s_waitcnt lgkmcnt(6)
    v_mfma_f32_32x32x16_bf16 v[32:47], v[72:75], v[216:219], v[32:47]
    ds_read_b64_tr_b16 v[72:73], v9 offset:10240
    ds_read_b64_tr_b16 v[74:75], v9 offset:10496
    s_waitcnt lgkmcnt(6)
    v_mfma_f32_32x32x16_bf16 v[32:47], v[76:79], v[220:223], v[32:47]
    ds_read_b64_tr_b16 v[76:77], v9 offset:11264
    ds_read_b64_tr_b16 v[78:79], v9 offset:11520
    s_waitcnt lgkmcnt(6)
    v_mfma_f32_32x32x16_bf16 v[32:47], v[64:67], v[224:227], v[32:47]
    s_add_u32 m0, s44, 67584
    s_add_u32 s47, s45, 885760
    buffer_load_dwordx4 v5, s[24:27], s47 offen lds
    ds_read_b64_tr_b16 v[64:65], v9 offset:12288
    ds_read_b64_tr_b16 v[66:67], v9 offset:12544
    s_waitcnt lgkmcnt(6)
    v_mfma_f32_32x32x16_bf16 v[32:47], v[68:71], v[228:231], v[32:47]
    ds_read_b64_tr_b16 v[68:69], v9 offset:13312
    ds_read_b64_tr_b16 v[70:71], v9 offset:13568
    s_waitcnt lgkmcnt(6)
    v_mfma_f32_32x32x16_bf16 v[32:47], v[72:75], v[232:235], v[32:47]
    ds_read_b64_tr_b16 v[72:73], v9 offset:14336
    ds_read_b64_tr_b16 v[74:75], v9 offset:14592
    s_waitcnt lgkmcnt(6)
    v_mfma_f32_32x32x16_bf16 v[32:47], v[76:79], v[236:239], v[32:47]
    ds_read_b64_tr_b16 v[76:77], v9 offset:15360
    ds_read_b64_tr_b16 v[78:79], v9 offset:15616
    s_waitcnt lgkmcnt(6)
    v_mfma_f32_32x32x16_bf16 v[32:47], v[64:67], v[240:243], v[32:47]
    s_add_u32 m0, s44, 68608
    s_add_u32 s48, s45, 934912
    buffer_load_dwordx4 v5, s[24:27], s48 offen lds
    s_waitcnt vmcnt(7)
    s_barrier
    v_add_u32 v9, 32768, v7
    s_waitcnt vmcnt(6)
    v_mul_f32 v105, v16, v16
    v_mul_f32 v104, 0xbfb8aa3b, v16
    v_mul_f32 v19, 0x3eb8aa3b, v16
    v_rcp_f32 v105, v105
    ds_read_b64_tr_b16 v[64:65], v9 offset:0
    ds_read_b64_tr_b16 v[66:67], v9 offset:256
    s_waitcnt lgkmcnt(6)
    v_mfma_f32_32x32x16_bf16 v[32:47], v[68:71], v[244:247], v[32:47]
    ds_read_b64_tr_b16 v[68:69], v9 offset:1024
    ds_read_b64_tr_b16 v[70:71], v9 offset:1280
    s_waitcnt lgkmcnt(6)
    v_mfma_f32_32x32x16_bf16 v[32:47], v[72:75], v[248:251], v[32:47]
    ds_read_b64_tr_b16 v[72:73], v9 offset:2048
    ds_read_b64_tr_b16 v[74:75], v9 offset:2304
    s_waitcnt lgkmcnt(6)
    v_mfma_f32_32x32x16_bf16 v[32:47], v[76:79], v[252:255], v[32:47]
    ds_read_b64_tr_b16 v[76:77], v9 offset:3072
    ds_read_b64_tr_b16 v[78:79], v9 offset:3328
    s_waitcnt lgkmcnt(6)
    v_mfma_f32_32x32x16_bf16 v[48:63], v[64:67], v[128:131], 0
    s_add_u32 m0, s44, 98304
    s_add_u32 s47, s46, 0
    buffer_load_dwordx4 v6, s[28:31], s47 offen lds
    ds_read_b64_tr_b16 v[64:65], v9 offset:4096
    ds_read_b64_tr_b16 v[66:67], v9 offset:4352
    s_waitcnt lgkmcnt(6)
    v_mfma_f32_32x32x16_bf16 v[48:63], v[68:71], v[132:135], v[48:63]
    ds_read_b64_tr_b16 v[68:69], v9 offset:5120
    ds_read_b64_tr_b16 v[70:71], v9 offset:5376
    s_waitcnt lgkmcnt(6)
    v_mfma_f32_32x32x16_bf16 v[48:63], v[72:75], v[136:139], v[48:63]
    v_mul_f32 v32, v32, v19
    v_mul_f32 v33, v33, v19
    v_mul_f32 v34, v34, v19
    ds_read_b64_tr_b16 v[72:73], v9 offset:6144
    ds_read_b64_tr_b16 v[74:75], v9 offset:6400
    s_waitcnt lgkmcnt(6)
    v_mfma_f32_32x32x16_bf16 v[48:63], v[76:79], v[140:143], v[48:63]
    v_mul_f32 v35, v35, v19
    v_mul_f32 v36, v36, v19
    v_mul_f32 v37, v37, v19
    ds_read_b64_tr_b16 v[76:77], v9 offset:7168
    ds_read_b64_tr_b16 v[78:79], v9 offset:7424
    s_waitcnt lgkmcnt(6)
    v_mfma_f32_32x32x16_bf16 v[48:63], v[64:67], v[144:147], v[48:63]
    s_add_u32 m0, s44, 99328
    s_add_u32 s48, s46, 57344
    buffer_load_dwordx4 v6, s[28:31], s48 offen lds
    v_mul_f32 v38, v38, v19
    v_mul_f32 v39, v39, v19
    v_mul_f32 v40, v40, v19
    ds_read_b64_tr_b16 v[64:65], v9 offset:8192
    ds_read_b64_tr_b16 v[66:67], v9 offset:8448
    s_waitcnt lgkmcnt(6)
    v_mfma_f32_32x32x16_bf16 v[48:63], v[68:71], v[148:151], v[48:63]
    v_mul_f32 v41, v41, v19
    v_mul_f32 v42, v42, v19
    v_mul_f32 v43, v43, v19
    ds_read_b64_tr_b16 v[68:69], v9 offset:9216
    ds_read_b64_tr_b16 v[70:71], v9 offset:9472
    s_waitcnt lgkmcnt(6)
    v_mfma_f32_32x32x16_bf16 v[48:63], v[72:75], v[152:155], v[48:63]
    v_mul_f32 v44, v44, v19
    v_mul_f32 v45, v45, v19
    v_mul_f32 v46, v46, v19
    ds_read_b64_tr_b16 v[72:73], v9 offset:10240
    ds_read_b64_tr_b16 v[74:75], v9 offset:10496
    s_waitcnt lgkmcnt(6)
    v_mfma_f32_32x32x16_bf16 v[48:63], v[76:79], v[156:159], v[48:63]
    v_mul_f32 v47, v47, v19
    v_cvt_pk_bf16_f32 v80, v32, v33
    v_cvt_pk_bf16_f32 v81, v34, v35
    ds_read_b64_tr_b16 v[76:77], v9 offset:11264
    ds_read_b64_tr_b16 v[78:79], v9 offset:11520
    s_waitcnt lgkmcnt(6)
    v_mfma_f32_32x32x16_bf16 v[48:63], v[64:67], v[160:163], v[48:63]
    s_add_u32 m0, s44, 100352
    s_add_u32 s47, s46, 114688
    buffer_load_dwordx4 v6, s[28:31], s47 offen lds
    v_cvt_pk_bf16_f32 v82, v36, v37
    v_cvt_pk_bf16_f32 v83, v38, v39
    v_cvt_pk_bf16_f32 v84, v40, v41
    ds_read_b64_tr_b16 v[64:65], v9 offset:12288
    ds_read_b64_tr_b16 v[66:67], v9 offset:12544
    s_waitcnt lgkmcnt(6)
    v_mfma_f32_32x32x16_bf16 v[48:63], v[68:71], v[164:167], v[48:63]
    v_cvt_pk_bf16_f32 v85, v42, v43
    v_cvt_pk_bf16_f32 v86, v44, v45
    v_cvt_pk_bf16_f32 v87, v46, v47
    s_add_u32 s67, s49, 0x0
    buffer_store_dwordx4 v[80:83], v2, s[36:39], s67 offen sc1
    s_add_u32 s67, s49, 0x10000
    buffer_store_dwordx4 v[84:87], v2, s[36:39], s67 offen sc1
    ds_read_b64_tr_b16 v[68:69], v9 offset:13312
    ds_read_b64_tr_b16 v[70:71], v9 offset:13568
    s_waitcnt lgkmcnt(6)
    v_mfma_f32_32x32x16_bf16 v[48:63], v[72:75], v[168:171], v[48:63]
    ds_read_b64_tr_b16 v[72:73], v9 offset:14336
    ds_read_b64_tr_b16 v[74:75], v9 offset:14592
    s_waitcnt lgkmcnt(6)
    v_mfma_f32_32x32x16_bf16 v[48:63], v[76:79], v[172:175], v[48:63]
    ds_read_b64_tr_b16 v[76:77], v9 offset:15360
    ds_read_b64_tr_b16 v[78:79], v9 offset:15616
    s_waitcnt lgkmcnt(6)
    v_mfma_f32_32x32x16_bf16 v[48:63], v[64:67], v[176:179], v[48:63]
    s_add_u32 m0, s44, 101376
    s_add_u32 s48, s46, 172032
    buffer_load_dwordx4 v6, s[28:31], s48 offen lds
    s_waitcnt vmcnt(6)
    s_barrier
    v_add_u32 v9, 65536, v7
    ds_read_b64_tr_b16 v[64:65], v9 offset:0
    ds_read_b64_tr_b16 v[66:67], v9 offset:256
    s_waitcnt lgkmcnt(6)
    v_mfma_f32_32x32x16_bf16 v[48:63], v[68:71], v[180:183], v[48:63]
    ds_read_b64_tr_b16 v[68:69], v9 offset:1024
    ds_read_b64_tr_b16 v[70:71], v9 offset:1280
    s_waitcnt lgkmcnt(6)
    v_mfma_f32_32x32x16_bf16 v[48:63], v[72:75], v[184:187], v[48:63]
    ds_read_b64_tr_b16 v[72:73], v9 offset:2048
    ds_read_b64_tr_b16 v[74:75], v9 offset:2304
    s_waitcnt lgkmcnt(6)
    v_mfma_f32_32x32x16_bf16 v[48:63], v[76:79], v[188:191], v[48:63]
    ds_read_b64_tr_b16 v[76:77], v9 offset:3072
    ds_read_b64_tr_b16 v[78:79], v9 offset:3328
    s_waitcnt lgkmcnt(6)
    v_mfma_f32_32x32x16_bf16 v[48:63], v[64:67], v[192:195], v[48:63]
    s_add_u32 m0, s44, 131072
    s_add_u32 s47, s46, 917504
    buffer_load_dwordx4 v6, s[28:31], s47 offen lds
    ds_read_b64_tr_b16 v[64:65], v9 offset:4096
    ds_read_b64_tr_b16 v[66:67], v9 offset:4352
    s_waitcnt lgkmcnt(6)
    v_mfma_f32_32x32x16_bf16 v[48:63], v[68:71], v[196:199], v[48:63]
    ds_read_b64_tr_b16 v[68:69], v9 offset:5120
    ds_read_b64_tr_b16 v[70:71], v9 offset:5376
    s_waitcnt lgkmcnt(6)
    v_mfma_f32_32x32x16_bf16 v[48:63], v[72:75], v[200:203], v[48:63]
    ds_read_b64_tr_b16 v[72:73], v9 offset:6144
    ds_read_b64_tr_b16 v[74:75], v9 offset:6400
    s_waitcnt lgkmcnt(6)
    v_mfma_f32_32x32x16_bf16 v[48:63], v[76:79], v[204:207], v[48:63]
    ds_read_b64_tr_b16 v[76:77], v9 offset:7168
    ds_read_b64_tr_b16 v[78:79], v9 offset:7424
    s_waitcnt lgkmcnt(6)
    v_mfma_f32_32x32x16_bf16 v[48:63], v[64:67], v[208:211], v[48:63]
    s_add_u32 m0, s44, 132096
    s_add_u32 s48, s46, 974848
    buffer_load_dwordx4 v6, s[28:31], s48 offen lds
    ds_read_b64_tr_b16 v[64:65], v9 offset:8192
    ds_read_b64_tr_b16 v[66:67], v9 offset:8448
    s_waitcnt lgkmcnt(6)
    v_mfma_f32_32x32x16_bf16 v[48:63], v[68:71], v[212:215], v[48:63]
    ds_read_b64_tr_b16 v[68:69], v9 offset:9216
    ds_read_b64_tr_b16 v[70:71], v9 offset:9472
    s_waitcnt lgkmcnt(6)
    v_mfma_f32_32x32x16_bf16 v[48:63], v[72:75], v[216:219], v[48:63]
    ds_read_b64_tr_b16 v[72:73], v9 offset:10240
    ds_read_b64_tr_b16 v[74:75], v9 offset:10496
    s_waitcnt lgkmcnt(6)
    v_mfma_f32_32x32x16_bf16 v[48:63], v[76:79], v[220:223], v[48:63]
    ds_read_b64_tr_b16 v[76:77], v9 offset:11264
    ds_read_b64_tr_b16 v[78:79], v9 offset:11520
    s_waitcnt lgkmcnt(6)
    v_mfma_f32_32x32x16_bf16 v[48:63], v[64:67], v[224:227], v[48:63]
    s_add_u32 m0, s44, 133120
    s_add_u32 s47, s46, 1032192
    buffer_load_dwordx4 v6, s[28:31], s47 offen lds
    ds_read_b64_tr_b16 v[64:65], v9 offset:12288
    ds_read_b64_tr_b16 v[66:67], v9 offset:12544
    s_waitcnt lgkmcnt(6)
    v_mfma_f32_32x32x16_bf16 v[48:63], v[68:71], v[228:231], v[48:63]
    ds_read_b64_tr_b16 v[68:69], v9 offset:13312
    ds_read_b64_tr_b16 v[70:71], v9 offset:13568
    s_waitcnt lgkmcnt(6)
    v_mfma_f32_32x32x16_bf16 v[48:63], v[72:75], v[232:235], v[48:63]
    ds_read_b64_tr_b16 v[72:73], v9 offset:14336
    ds_read_b64_tr_b16 v[74:75], v9 offset:14592
    s_waitcnt lgkmcnt(6)
    v_mfma_f32_32x32x16_bf16 v[48:63], v[76:79], v[236:239], v[48:63]
    ds_read_b64_tr_b16 v[76:77], v9 offset:15360
    ds_read_b64_tr_b16 v[78:79], v9 offset:15616
    s_waitcnt lgkmcnt(6)
    v_mfma_f32_32x32x16_bf16 v[48:63], v[64:67], v[240:243], v[48:63]
    s_add_u32 m0, s44, 134144
    s_add_u32 s48, s46, 1089536
    buffer_load_dwordx4 v6, s[28:31], s48 offen lds
    s_waitcnt vmcnt(4)
    s_barrier
    v_add_u32 v9, 98304, v8
    s_bfe_u32 s65, s2, 0x10003
    s_lshl_b32 s65, s65, 7
    v_mov_b32 v28, 1
    buffer_atomic_add v28, v31, s[68:71], s65 offen sc1
    ds_read_b64_tr_b16 v[64:65], v9 offset:0
    ds_read_b64_tr_b16 v[66:67], v9 offset:256
    s_waitcnt lgkmcnt(6)
    v_mfma_f32_32x32x16_bf16 v[48:63], v[68:71], v[244:247], v[48:63]
    ds_read_b64_tr_b16 v[68:69], v9 offset:1024
    ds_read_b64_tr_b16 v[70:71], v9 offset:1280
    s_waitcnt lgkmcnt(6)
    v_mfma_f32_32x32x16_bf16 v[48:63], v[72:75], v[248:251], v[48:63]
    ds_read_b64_tr_b16 v[72:73], v9 offset:2048
    ds_read_b64_tr_b16 v[74:75], v9 offset:2304
    s_waitcnt lgkmcnt(6)
    v_mfma_f32_32x32x16_bf16 v[48:63], v[76:79], v[252:255], v[48:63]
    ds_read_b64_tr_b16 v[76:77], v9 offset:3072
    ds_read_b64_tr_b16 v[78:79], v9 offset:3328
    s_waitcnt lgkmcnt(6)
    v_mfma_f32_32x32x16_bf16 v[32:47], v[64:67], v[128:131], 0
    s_add_u32 m0, s44, 0
    s_add_u32 s47, s46, 64
    buffer_load_dwordx4 v6, s[28:31], s47 offen lds
    ds_read_b64_tr_b16 v[64:65], v9 offset:4096
    ds_read_b64_tr_b16 v[66:67], v9 offset:4352
    s_waitcnt lgkmcnt(6)
    v_mfma_f32_32x32x16_bf16 v[32:47], v[68:71], v[132:135], v[32:47]
    ds_read_b64_tr_b16 v[68:69], v9 offset:5120
    ds_read_b64_tr_b16 v[70:71], v9 offset:5376
    s_waitcnt lgkmcnt(6)
    v_mfma_f32_32x32x16_bf16 v[32:47], v[72:75], v[136:139], v[32:47]
    v_mul_f32 v48, v48, v16
    v_mul_f32 v49, v49, v16
    v_mul_f32 v50, v50, v16
    ds_read_b64_tr_b16 v[72:73], v9 offset:6144
    ds_read_b64_tr_b16 v[74:75], v9 offset:6400
    s_waitcnt lgkmcnt(6)
    v_mfma_f32_32x32x16_bf16 v[32:47], v[76:79], v[140:143], v[32:47]
    v_mul_f32 v51, v51, v16
    v_mul_f32 v52, v52, v16
    v_mul_f32 v53, v53, v16
    ds_read_b64_tr_b16 v[76:77], v9 offset:7168
    ds_read_b64_tr_b16 v[78:79], v9 offset:7424
    s_waitcnt lgkmcnt(6)
    v_mfma_f32_32x32x16_bf16 v[32:47], v[64:67], v[144:147], v[32:47]
    s_add_u32 m0, s44, 1024
    s_add_u32 s48, s46, 57408
    buffer_load_dwordx4 v6, s[28:31], s48 offen lds
    v_mul_f32 v54, v54, v16
    v_mul_f32 v55, v55, v16
    v_mul_f32 v56, v56, v16
    ds_read_b64_tr_b16 v[64:65], v9 offset:8192
    ds_read_b64_tr_b16 v[66:67], v9 offset:8448
    s_waitcnt lgkmcnt(6)
    v_mfma_f32_32x32x16_bf16 v[32:47], v[68:71], v[148:151], v[32:47]
    v_mul_f32 v57, v57, v16
    v_mul_f32 v58, v58, v16
    v_mul_f32 v59, v59, v16
    ds_read_b64_tr_b16 v[68:69], v9 offset:9216
    ds_read_b64_tr_b16 v[70:71], v9 offset:9472
    s_waitcnt lgkmcnt(6)
    v_mfma_f32_32x32x16_bf16 v[32:47], v[72:75], v[152:155], v[32:47]
    v_mul_f32 v60, v60, v16
    v_mul_f32 v61, v61, v16
    v_mul_f32 v62, v62, v16
    ds_read_b64_tr_b16 v[72:73], v9 offset:10240
    ds_read_b64_tr_b16 v[74:75], v9 offset:10496
    s_waitcnt lgkmcnt(6)
    v_mfma_f32_32x32x16_bf16 v[32:47], v[76:79], v[156:159], v[32:47]
    v_mul_f32 v63, v63, v16
    v_cvt_pk_bf16_f32 v80, v48, v49
    v_cvt_pk_bf16_f32 v81, v50, v51
    ds_read_b64_tr_b16 v[76:77], v9 offset:11264
    ds_read_b64_tr_b16 v[78:79], v9 offset:11520
    s_waitcnt lgkmcnt(6)
    v_mfma_f32_32x32x16_bf16 v[32:47], v[64:67], v[160:163], v[32:47]
    s_add_u32 m0, s44, 2048
    s_add_u32 s47, s46, 114752
    buffer_load_dwordx4 v6, s[28:31], s47 offen lds
    v_cvt_pk_bf16_f32 v82, v52, v53
    v_cvt_pk_bf16_f32 v83, v54, v55
    v_cvt_pk_bf16_f32 v84, v56, v57
    ds_read_b64_tr_b16 v[64:65], v9 offset:12288
    ds_read_b64_tr_b16 v[66:67], v9 offset:12544
    s_waitcnt lgkmcnt(6)
    v_mfma_f32_32x32x16_bf16 v[32:47], v[68:71], v[164:167], v[32:47]
    v_cvt_pk_bf16_f32 v85, v58, v59
    v_cvt_pk_bf16_f32 v86, v60, v61
    v_cvt_pk_bf16_f32 v87, v62, v63
    s_add_u32 s67, s49, 0x200000
    buffer_store_dwordx4 v[80:83], v3, s[36:39], s67 offen sc1
    s_add_u32 s67, s49, 0x210000
    buffer_store_dwordx4 v[84:87], v3, s[36:39], s67 offen sc1
    ds_read_b64_tr_b16 v[68:69], v9 offset:13312
    ds_read_b64_tr_b16 v[70:71], v9 offset:13568
    s_waitcnt lgkmcnt(6)
    v_mfma_f32_32x32x16_bf16 v[32:47], v[72:75], v[168:171], v[32:47]
    ds_read_b64_tr_b16 v[72:73], v9 offset:14336
    ds_read_b64_tr_b16 v[74:75], v9 offset:14592
    s_waitcnt lgkmcnt(6)
    v_mfma_f32_32x32x16_bf16 v[32:47], v[76:79], v[172:175], v[32:47]
    ds_read_b64_tr_b16 v[76:77], v9 offset:15360
    ds_read_b64_tr_b16 v[78:79], v9 offset:15616
    s_waitcnt lgkmcnt(6)
    v_mfma_f32_32x32x16_bf16 v[32:47], v[64:67], v[176:179], v[32:47]
    s_add_u32 m0, s44, 3072
    s_add_u32 s48, s46, 172096
    buffer_load_dwordx4 v6, s[28:31], s48 offen lds
    s_waitcnt vmcnt(7)
    s_barrier
    v_add_u32 v9, 131072, v8
    ds_read_b64_tr_b16 v[64:65], v9 offset:0
    ds_read_b64_tr_b16 v[66:67], v9 offset:256
    s_waitcnt lgkmcnt(6)
    v_mfma_f32_32x32x16_bf16 v[32:47], v[68:71], v[180:183], v[32:47]
    ds_read_b64_tr_b16 v[68:69], v9 offset:1024
    ds_read_b64_tr_b16 v[70:71], v9 offset:1280
    s_waitcnt lgkmcnt(6)
    v_mfma_f32_32x32x16_bf16 v[32:47], v[72:75], v[184:187], v[32:47]
    ds_read_b64_tr_b16 v[72:73], v9 offset:2048
    ds_read_b64_tr_b16 v[74:75], v9 offset:2304
    s_waitcnt lgkmcnt(6)
    v_mfma_f32_32x32x16_bf16 v[32:47], v[76:79], v[188:191], v[32:47]
    ds_read_b64_tr_b16 v[76:77], v9 offset:3072
    ds_read_b64_tr_b16 v[78:79], v9 offset:3328
    s_waitcnt lgkmcnt(6)
    v_mfma_f32_32x32x16_bf16 v[32:47], v[64:67], v[192:195], v[32:47]
    s_add_u32 m0, s44, 32768
    s_add_u32 s47, s46, 917568
    buffer_load_dwordx4 v6, s[28:31], s47 offen lds
    ds_read_b64_tr_b16 v[64:65], v9 offset:4096
    ds_read_b64_tr_b16 v[66:67], v9 offset:4352
    s_waitcnt lgkmcnt(6)
    v_mfma_f32_32x32x16_bf16 v[32:47], v[68:71], v[196:199], v[32:47]
    ds_read_b64_tr_b16 v[68:69], v9 offset:5120
    ds_read_b64_tr_b16 v[70:71], v9 offset:5376
    s_waitcnt lgkmcnt(6)
    v_mfma_f32_32x32x16_bf16 v[32:47], v[72:75], v[200:203], v[32:47]
    ds_read_b64_tr_b16 v[72:73], v9 offset:6144
    ds_read_b64_tr_b16 v[74:75], v9 offset:6400
    s_waitcnt lgkmcnt(6)
    v_mfma_f32_32x32x16_bf16 v[32:47], v[76:79], v[204:207], v[32:47]
    ds_read_b64_tr_b16 v[76:77], v9 offset:7168
    ds_read_b64_tr_b16 v[78:79], v9 offset:7424
    s_waitcnt lgkmcnt(6)
    v_mfma_f32_32x32x16_bf16 v[32:47], v[64:67], v[208:211], v[32:47]
    s_add_u32 m0, s44, 33792
    s_add_u32 s48, s46, 974912
    buffer_load_dwordx4 v6, s[28:31], s48 offen lds
    ds_read_b64_tr_b16 v[64:65], v9 offset:8192
    ds_read_b64_tr_b16 v[66:67], v9 offset:8448
    s_waitcnt lgkmcnt(6)
    v_mfma_f32_32x32x16_bf16 v[32:47], v[68:71], v[212:215], v[32:47]
    ds_read_b64_tr_b16 v[68:69], v9 offset:9216
    ds_read_b64_tr_b16 v[70:71], v9 offset:9472
    s_waitcnt lgkmcnt(6)
    v_mfma_f32_32x32x16_bf16 v[32:47], v[72:75], v[216:219], v[32:47]
    ds_read_b64_tr_b16 v[72:73], v9 offset:10240
    ds_read_b64_tr_b16 v[74:75], v9 offset:10496
    s_waitcnt lgkmcnt(6)
    v_mfma_f32_32x32x16_bf16 v[32:47], v[76:79], v[220:223], v[32:47]
    ds_read_b64_tr_b16 v[76:77], v9 offset:11264
    ds_read_b64_tr_b16 v[78:79], v9 offset:11520
    s_waitcnt lgkmcnt(6)
    v_mfma_f32_32x32x16_bf16 v[32:47], v[64:67], v[224:227], v[32:47]
    s_add_u32 m0, s44, 34816
    s_add_u32 s47, s46, 1032256
    buffer_load_dwordx4 v6, s[28:31], s47 offen lds
    ds_read_b64_tr_b16 v[64:65], v9 offset:12288
    ds_read_b64_tr_b16 v[66:67], v9 offset:12544
    s_waitcnt lgkmcnt(6)
    v_mfma_f32_32x32x16_bf16 v[32:47], v[68:71], v[228:231], v[32:47]
    ds_read_b64_tr_b16 v[68:69], v9 offset:13312
    ds_read_b64_tr_b16 v[70:71], v9 offset:13568
    s_waitcnt lgkmcnt(6)
    v_mfma_f32_32x32x16_bf16 v[32:47], v[72:75], v[232:235], v[32:47]
    ds_read_b64_tr_b16 v[72:73], v9 offset:14336
    ds_read_b64_tr_b16 v[74:75], v9 offset:14592
    s_waitcnt lgkmcnt(6)
    v_mfma_f32_32x32x16_bf16 v[32:47], v[76:79], v[236:239], v[32:47]
    ds_read_b64_tr_b16 v[76:77], v9 offset:15360
    ds_read_b64_tr_b16 v[78:79], v9 offset:15616
    s_waitcnt lgkmcnt(6)
    v_mfma_f32_32x32x16_bf16 v[32:47], v[64:67], v[240:243], v[32:47]
    s_add_u32 m0, s44, 35840
    s_add_u32 s48, s46, 1089600
    buffer_load_dwordx4 v6, s[28:31], s48 offen lds
    s_waitcnt vmcnt(4)
    s_barrier
    v_add_u32 v9, 0, v8
    v_mov_b32 v28, 1
    buffer_store_dword v28, v31, s[36:39], s97 offen sc1
    v_bfe_u32 v26, v2, 4, 6
    v_bfe_u32 v27, v26, 1, 4
    v_and_b32 v28, 1, v26
    s_lshr_b32 s65, s93, 2
    s_lshl_b32 s65, s65, 1
    v_add_u32 v28, s65, v28
    v_lshrrev_b32 v29, 2, v27
    v_lshrrev_b32 v25, 3, v28
    v_lshl_add_u32 v29, v25, 2, v29
    v_and_b32 v25, 3, v27
    v_lshl_add_u32 v29, v25, 3, v29
    v_and_b32 v25, 7, v28
    v_lshl_add_u32 v29, v25, 5, v29
    v_lshlrev_b32 v29, 7, v29
    v_add_u32 v29, 0xb00000, v29
    s_cmp_eq_u32 s40, 0
    s_cselect_b32 s65, 0, 0x40000000
    v_add_u32 v29, s65, v29
    v_bfe_u32 v28, v2, 4, 1
    v_lshlrev_b32 v28, 7, v28
    s_cmp_eq_u32 s40, 0
    s_cselect_b32 s65, 0, 0x40000000
    v_add_u32 v28, s65, v28
    buffer_load_dword v27, v28, s[68:71], 0 offen sc1
    ds_read_b64_tr_b16 v[64:65], v9 offset:0
    ds_read_b64_tr_b16 v[66:67], v9 offset:256
    s_waitcnt lgkmcnt(6)
    v_mfma_f32_32x32x16_bf16 v[32:47], v[68:71], v[244:247], v[32:47]
    ds_read_b64_tr_b16 v[68:69], v9 offset:1024
    ds_read_b64_tr_b16 v[70:71], v9 offset:1280
    s_waitcnt lgkmcnt(6)
    v_mfma_f32_32x32x16_bf16 v[32:47], v[72:75], v[248:251], v[32:47]
    ds_read_b64_tr_b16 v[72:73], v9 offset:2048
    ds_read_b64_tr_b16 v[74:75], v9 offset:2304
    s_waitcnt lgkmcnt(6)
    v_mfma_f32_32x32x16_bf16 v[32:47], v[76:79], v[252:255], v[32:47]
    ds_read_b64_tr_b16 v[76:77], v9 offset:3072
    ds_read_b64_tr_b16 v[78:79], v9 offset:3328
    s_waitcnt lgkmcnt(6)
    v_mfma_f32_32x32x16_bf16 v[48:63], v[64:67], v[128:131], 0
    s_add_u32 m0, s44, 65536
    s_add_u32 s47, s46, 128
    buffer_load_dwordx4 v6, s[28:31], s47 offen lds
    ds_read_b64_tr_b16 v[64:65], v9 offset:4096
    ds_read_b64_tr_b16 v[66:67], v9 offset:4352
    s_waitcnt lgkmcnt(6)
    v_mfma_f32_32x32x16_bf16 v[48:63], v[68:71], v[132:135], v[48:63]
    ds_read_b64_tr_b16 v[68:69], v9 offset:5120
    ds_read_b64_tr_b16 v[70:71], v9 offset:5376
    s_waitcnt lgkmcnt(6)
    v_mfma_f32_32x32x16_bf16 v[48:63], v[72:75], v[136:139], v[48:63]
    v_mul_f32 v80, v32, v104
    v_mul_f32 v81, v33, v104
    v_mul_f32 v82, v34, v104
    ds_read_b64_tr_b16 v[72:73], v9 offset:6144
    ds_read_b64_tr_b16 v[74:75], v9 offset:6400
    s_waitcnt lgkmcnt(6)
    v_mfma_f32_32x32x16_bf16 v[48:63], v[76:79], v[140:143], v[48:63]
    v_mul_f32 v83, v35, v104
    v_mul_f32 v84, v36, v104
    v_mul_f32 v85, v37, v104
    ds_read_b64_tr_b16 v[76:77], v9 offset:7168
    ds_read_b64_tr_b16 v[78:79], v9 offset:7424
    s_waitcnt lgkmcnt(6)
    v_mfma_f32_32x32x16_bf16 v[48:63], v[64:67], v[144:147], v[48:63]
    s_add_u32 m0, s44, 66560
    s_add_u32 s48, s46, 57472
    buffer_load_dwordx4 v6, s[28:31], s48 offen lds
    v_mul_f32 v86, v38, v104
    v_mul_f32 v87, v39, v104
    v_exp_f32 v80, v80
    ds_read_b64_tr_b16 v[64:65], v9 offset:8192
    ds_read_b64_tr_b16 v[66:67], v9 offset:8448
    s_waitcnt lgkmcnt(6)
    v_mfma_f32_32x32x16_bf16 v[48:63], v[68:71], v[148:151], v[48:63]
    v_exp_f32 v81, v81
    v_exp_f32 v82, v82
    v_exp_f32 v83, v83
    ds_read_b64_tr_b16 v[68:69], v9 offset:9216
    ds_read_b64_tr_b16 v[70:71], v9 offset:9472
    s_waitcnt lgkmcnt(6)
    v_mfma_f32_32x32x16_bf16 v[48:63], v[72:75], v[152:155], v[48:63]
    v_exp_f32 v84, v84
    v_exp_f32 v85, v85
    v_exp_f32 v86, v86
    ds_read_b64_tr_b16 v[72:73], v9 offset:10240
    ds_read_b64_tr_b16 v[74:75], v9 offset:10496
    s_waitcnt lgkmcnt(6)
    v_mfma_f32_32x32x16_bf16 v[48:63], v[76:79], v[156:159], v[48:63]
    v_exp_f32 v87, v87
    v_mul_f32 v40, v32, v40
    v_mul_f32 v41, v33, v41
    ds_read_b64_tr_b16 v[76:77], v9 offset:11264
    ds_read_b64_tr_b16 v[78:79], v9 offset:11520
    s_waitcnt lgkmcnt(6)
    v_mfma_f32_32x32x16_bf16 v[48:63], v[64:67], v[160:163], v[48:63]
    s_add_u32 m0, s44, 67584
    s_add_u32 s47, s46, 114816
    buffer_load_dwordx4 v6, s[28:31], s47 offen lds
    v_mul_f32 v42, v34, v42
    v_mul_f32 v43, v35, v43
    v_mul_f32 v44, v36, v44
    ds_read_b64_tr_b16 v[64:65], v9 offset:12288
    ds_read_b64_tr_b16 v[66:67], v9 offset:12544
    s_waitcnt lgkmcnt(6)
    v_mfma_f32_32x32x16_bf16 v[48:63], v[68:71], v[164:167], v[48:63]
    v_mul_f32 v45, v37, v45
    v_mul_f32 v46, v38, v46
    v_mul_f32 v47, v39, v47
    ds_read_b64_tr_b16 v[68:69], v9 offset:13312
    ds_read_b64_tr_b16 v[70:71], v9 offset:13568
    s_waitcnt lgkmcnt(6)
    v_mfma_f32_32x32x16_bf16 v[48:63], v[72:75], v[168:171], v[48:63]
    v_fma_f32 v80, v80, v105, v105
    v_fma_f32 v81, v81, v105, v105
    v_fma_f32 v82, v82, v105, v105
    ds_read_b64_tr_b16 v[72:73], v9 offset:14336
    ds_read_b64_tr_b16 v[74:75], v9 offset:14592
    s_waitcnt lgkmcnt(6)
    v_mfma_f32_32x32x16_bf16 v[48:63], v[76:79], v[172:175], v[48:63]
    v_fma_f32 v83, v83, v105, v105
    v_fma_f32 v84, v84, v105, v105
    v_fma_f32 v85, v85, v105, v105
    ds_read_b64_tr_b16 v[76:77], v9 offset:15360
    ds_read_b64_tr_b16 v[78:79], v9 offset:15616
    s_waitcnt lgkmcnt(6)
    v_mfma_f32_32x32x16_bf16 v[48:63], v[64:67], v[176:179], v[48:63]
    s_add_u32 m0, s44, 68608
    s_add_u32 s48, s46, 172160
    buffer_load_dwordx4 v6, s[28:31], s48 offen lds
    v_fma_f32 v86, v86, v105, v105
    v_fma_f32 v87, v87, v105, v105
    v_rcp_f32 v80, v80
    s_waitcnt vmcnt(6)
    s_waitcnt vmcnt(4)
    s_cmp_lg_u32 s40, 0
    s_cbranch_scc1 L_ok0
    v_mov_b32 v28, 128
    v_cmp_gt_u32 vcc, v28, v27
    s_nop 4
    s_cbranch_vccz L_ok0
    s_mov_b32 s98, 0
L_spin0:
    v_bfe_u32 v28, v2, 4, 1
    v_lshlrev_b32 v28, 7, v28
    s_cmp_eq_u32 s40, 0
    s_cselect_b32 s65, 0, 0x40000000
    v_add_u32 v28, s65, v28
    buffer_load_dword v27, v28, s[68:71], 0 offen sc1
    s_waitcnt vmcnt(0)
    v_mov_b32 v28, 128
    v_cmp_gt_u32 vcc, v28, v27
    s_add_u32 s98, s98, 1
    s_cmp_gt_u32 s98, 200000
    s_cbranch_scc1 L_ok0
    s_nop 1
    s_cbranch_vccnz L_spin0
L_ok0:
    s_barrier
    v_add_u32 v9, 32768, v8
    buffer_load_dword v30, v29, s[36:39], 0 offen sc1
    ds_read_b64_tr_b16 v[64:65], v9 offset:0
    ds_read_b64_tr_b16 v[66:67], v9 offset:256
    s_waitcnt lgkmcnt(6)
    v_mfma_f32_32x32x16_bf16 v[48:63], v[68:71], v[180:183], v[48:63]
    v_rcp_f32 v81, v81
    v_rcp_f32 v82, v82
    v_rcp_f32 v83, v83
    ds_read_b64_tr_b16 v[68:69], v9 offset:1024
    ds_read_b64_tr_b16 v[70:71], v9 offset:1280
    s_waitcnt lgkmcnt(6)
    v_mfma_f32_32x32x16_bf16 v[48:63], v[72:75], v[184:187], v[48:63]
    v_rcp_f32 v84, v84
    v_rcp_f32 v85, v85
    v_rcp_f32 v86, v86
    ds_read_b64_tr_b16 v[72:73], v9 offset:2048
    ds_read_b64_tr_b16 v[74:75], v9 offset:2304
    s_waitcnt lgkmcnt(6)
    v_mfma_f32_32x32x16_bf16 v[48:63], v[76:79], v[188:191], v[48:63]
    v_rcp_f32 v87, v87
    v_mul_f32 v40, v40, v80
    v_mul_f32 v41, v41, v81
    ds_read_b64_tr_b16 v[76:77], v9 offset:3072
    ds_read_b64_tr_b16 v[78:79], v9 offset:3328
    s_waitcnt lgkmcnt(6)
    v_mfma_f32_32x32x16_bf16 v[48:63], v[64:67], v[192:195], v[48:63]
    s_add_u32 m0, s44, 98304
    s_add_u32 s47, s46, 917632
    buffer_load_dwordx4 v6, s[28:31], s47 offen lds
    v_mul_f32 v42, v42, v82
    v_mul_f32 v43, v43, v83
    v_mul_f32 v44, v44, v84
    ds_read_b64_tr_b16 v[64:65], v9 offset:4096
    ds_read_b64_tr_b16 v[66:67], v9 offset:4352
    s_waitcnt lgkmcnt(6)
    v_mfma_f32_32x32x16_bf16 v[48:63], v[68:71], v[196:199], v[48:63]
    v_mul_f32 v45, v45, v85
    v_mul_f32 v46, v46, v86
    v_mul_f32 v47, v47, v87
    ds_read_b64_tr_b16 v[68:69], v9 offset:5120
    ds_read_b64_tr_b16 v[70:71], v9 offset:5376
    s_waitcnt lgkmcnt(6)
    v_mfma_f32_32x32x16_bf16 v[48:63], v[72:75], v[200:203], v[48:63]
    v_cvt_pk_bf16_f32 v88, v40, v41
    v_cvt_pk_bf16_f32 v89, v42, v43
    v_cvt_pk_bf16_f32 v90, v44, v45
    ds_read_b64_tr_b16 v[72:73], v9 offset:6144
    ds_read_b64_tr_b16 v[74:75], v9 offset:6400
    s_waitcnt lgkmcnt(6)
    v_mfma_f32_32x32x16_bf16 v[48:63], v[76:79], v[204:207], v[48:63]
    v_cvt_pk_bf16_f32 v91, v46, v47
    ds_read_b64_tr_b16 v[76:77], v9 offset:7168
    ds_read_b64_tr_b16 v[78:79], v9 offset:7424
    s_waitcnt lgkmcnt(6)
    v_mfma_f32_32x32x16_bf16 v[48:63], v[64:67], v[208:211], v[48:63]
    s_add_u32 m0, s44, 99328
    s_add_u32 s48, s46, 974976
    buffer_load_dwordx4 v6, s[28:31], s48 offen lds
    ds_read_b64_tr_b16 v[64:65], v9 offset:8192
    ds_read_b64_tr_b16 v[66:67], v9 offset:8448
    s_waitcnt lgkmcnt(6)
    v_mfma_f32_32x32x16_bf16 v[48:63], v[68:71], v[212:215], v[48:63]
    ds_read_b64_tr_b16 v[68:69], v9 offset:9216
    ds_read_b64_tr_b16 v[70:71], v9 offset:9472
    s_waitcnt lgkmcnt(6)
    v_mfma_f32_32x32x16_bf16 v[48:63], v[72:75], v[216:219], v[48:63]
    ds_read_b64_tr_b16 v[72:73], v9 offset:10240
    ds_read_b64_tr_b16 v[74:75], v9 offset:10496
    s_waitcnt lgkmcnt(6)
    v_mfma_f32_32x32x16_bf16 v[48:63], v[76:79], v[220:223], v[48:63]
    ds_read_b64_tr_b16 v[76:77], v9 offset:11264
    ds_read_b64_tr_b16 v[78:79], v9 offset:11520
    s_waitcnt lgkmcnt(6)
    v_mfma_f32_32x32x16_bf16 v[48:63], v[64:67], v[224:227], v[48:63]
    s_add_u32 m0, s44, 100352
    s_add_u32 s47, s46, 1032320
    buffer_load_dwordx4 v6, s[28:31], s47 offen lds
    ds_read_b64_tr_b16 v[64:65], v9 offset:12288
    ds_read_b64_tr_b16 v[66:67], v9 offset:12544
    s_waitcnt lgkmcnt(6)
    v_mfma_f32_32x32x16_bf16 v[48:63], v[68:71], v[228:231], v[48:63]
    ds_read_b64_tr_b16 v[68:69], v9 offset:13312
    ds_read_b64_tr_b16 v[70:71], v9 offset:13568
    s_waitcnt lgkmcnt(6)
    v_mfma_f32_32x32x16_bf16 v[48:63], v[72:75], v[232:235], v[48:63]
    ds_read_b64_tr_b16 v[72:73], v9 offset:14336
    ds_read_b64_tr_b16 v[74:75], v9 offset:14592
    s_waitcnt lgkmcnt(6)
    v_mfma_f32_32x32x16_bf16 v[48:63], v[76:79], v[236:239], v[48:63]
    ds_read_b64_tr_b16 v[76:77], v9 offset:15360
    ds_read_b64_tr_b16 v[78:79], v9 offset:15616
    s_waitcnt lgkmcnt(6)
    v_mfma_f32_32x32x16_bf16 v[48:63], v[64:67], v[240:243], v[48:63]
    s_add_u32 m0, s44, 101376
    s_add_u32 s48, s46, 1089664
    buffer_load_dwordx4 v6, s[28:31], s48 offen lds
    s_waitcnt vmcnt(5)
    s_waitcnt vmcnt(4)
    s_cmp_lg_u32 s40, 0
    s_cbranch_scc1 L_ok1
    v_and_b32 v30, 1, v30
    v_cmp_ne_u32 vcc, 1, v30
    s_nop 4
    s_cbranch_vccz L_ok1
    s_mov_b32 s98, 0
L_spin1:
    buffer_load_dword v30, v29, s[36:39], 0 offen sc1
    s_waitcnt vmcnt(0)
    v_and_b32 v30, 1, v30
    v_cmp_ne_u32 vcc, 1, v30
    s_add_u32 s98, s98, 1
    s_cmp_gt_u32 s98, 200000
    s_cbranch_scc1 L_ok1
    s_nop 1
    s_cbranch_vccnz L_spin1
L_ok1:
    s_barrier
    v_add_u32 v9, 65536, v8
    s_lshl_b32 s65, s94, 3
    s_add_u32 s65, s65, s40
    s_lshl_b32 s66, s93, 6
    s_add_u32 s66, s66, s65
    s_lshl_b32 s66, s66, 10
    buffer_load_dwordx4 v[112:115], v2, s[36:39], s66 offen sc1
    ds_read_b64_tr_b16 v[64:65], v9 offset:0
    ds_read_b64_tr_b16 v[66:67], v9 offset:256
    s_waitcnt lgkmcnt(6)
    v_mfma_f32_32x32x16_bf16 v[48:63], v[68:71], v[244:247], v[48:63]
    s_add_u32 s67, s51, 0
    buffer_store_dwordx4 v[88:91], v2, s[36:39], s67 offen sc1
    ds_read_b64_tr_b16 v[68:69], v9 offset:1024
    ds_read_b64_tr_b16 v[70:71], v9 offset:1280
    s_waitcnt lgkmcnt(6)
    v_mfma_f32_32x32x16_bf16 v[48:63], v[72:75], v[248:251], v[48:63]
    v_lshlrev_b32 v26, 3, v0
    v_add_u32 v26, 131072, v26
    v_mov_b32 v24, 0x3f803f80
    ds_read_b64_tr_b16 v[72:73], v9 offset:2048
    ds_read_b64_tr_b16 v[74:75], v9 offset:2304
    s_waitcnt lgkmcnt(6)
    v_mfma_f32_32x32x16_bf16 v[48:63], v[76:79], v[252:255], v[48:63]
    v_mov_b32 v25, 0x3f803f80
    ds_write_b64 v26, v[24:25]
    v_mov_b32 v14, 0
    v_mov_b32 v15, 0
    ds_write_b64 v26, v[14:15] offset:4096
    v_bfe_u32 v24, v2, 4, 4
    v_lshlrev_b32 v24, 4, v24
    v_lshrrev_b32 v25, 9, v2
    v_lshl_add_u32 v24, v25, 8, v24
    v_add_u32 v24, 16384, v24
    v_bfe_u32 v25, v2, 4, 5
    v_subrev_u32 v26, 20, v25
    v_cmp_gt_u32 vcc, 8, v26
    v_mov_b32 v27, 135168
    v_mov_b32 v14, 135232
    v_cndmask_b32 v27, v27, v14, vcc
    v_cmp_eq_u32 vcc, 16, v25
    v_mov_b32 v14, 131264
    s_nop 0
    v_cndmask_b32 v27, v27, v14, vcc
    v_cmp_gt_u32 vcc, 16, v25
    v_mov_b32 v14, 4096
    v_mov_b32 v15, 20480
    v_cndmask_b32 v3, v27, v24, vcc
    v_cndmask_b32 v4, 0, v14, vcc
    v_cndmask_b32 v5, 0, v15, vcc
    v_add_u32 v10, 65536, v2
    ds_read_b64_tr_b16 v[76:77], v9 offset:3072
    ds_read_b64_tr_b16 v[78:79], v9 offset:3328
    s_waitcnt lgkmcnt(8)
    v_mfma_f32_32x32x16_bf16 v[32:47], v[64:67], v[128:131], 0
    s_add_u32 m0, s96, 0
    s_add_u32 s47, s95, 0x200000
    buffer_load_dwordx4 v2, s[36:39], s47 offen sc1 lds
    buffer_load_dwordx4 v2, s[36:39], s47 offen offset:1024 sc1 lds
    ds_read_b64_tr_b16 v[64:65], v9 offset:4096
    ds_read_b64_tr_b16 v[66:67], v9 offset:4352
    s_waitcnt lgkmcnt(8)
    v_mfma_f32_32x32x16_bf16 v[32:47], v[68:71], v[132:135], v[32:47]
    v_bfe_u32 v26, v2, 6, 4
    v_lshlrev_b32 v26, 10, v26
    v_bfe_u32 v27, v2, 4, 2
    v_lshl_add_u32 v26, v27, 4, v26
    s_lshr_b32 s65, s2, 4
    s_mul_i32 s65, s65, 9
    s_add_u32 s65, s65, s40
    s_and_b32 s66, s2, 15
    s_mul_i32 s57, s66, 144
    s_add_u32 s57, s57, s65
    s_lshl_b32 s57, s57, 10
    s_add_u32 s57, s57, 0x800000
    s_sub_u32 s67, s65, 112
    s_cmp_ge_u32 s65, 112
    s_cselect_b32 s65, s67, s65
    s_cselect_b32 s32, s8, s16
    s_cselect_b32 s33, s9, s17
    s_mov_b32 s34, 0x1c0000
    s_cselect_b32 s34, 0x80000, s34
    s_mov_b32 s35, 0x20000
    s_lshl_b32 s55, s65, 14
    s_lshl_b32 s66, s66, 6
    s_add_u32 s55, s55, s66
    s_lshl_b32 s66, s40, 11
    s_add_u32 m0, s66, 139264
    s_nop 0
    buffer_load_dwordx4 v26, s[32:35], s55 offen lds
    s_lshr_b32 s65, s2, 4
    s_mul_i32 s65, s65, 9
    s_add_u32 s65, s65, 8
    s_and_b32 s66, s2, 15
    s_mul_i32 s64, s66, 144
    s_add_u32 s64, s64, s65
    s_lshl_b32 s64, s64, 10
    s_add_u32 s64, s64, 0x800000
    s_sub_u32 s67, s65, 112
    s_cmp_ge_u32 s65, 112
    s_cselect_b32 s65, s67, s65
    s_cselect_b32 s60, s8, s16
    s_cselect_b32 s61, s9, s17
    s_mov_b32 s62, 0x1c0000
    s_cselect_b32 s62, 0x80000, s62
    s_mov_b32 s63, 0x20000
    s_lshl_b32 s58, s65, 14
    s_lshl_b32 s66, s66, 6
    s_add_u32 s58, s58, s66
    s_cmp_eq_u32 s40, 0
    s_cselect_b32 s64, s64, 0x1800000
    s_lshl_b32 s66, s40, 11
    s_add_u32 m0, s66, 140288
    s_nop 0
    buffer_load_dwordx4 v26, s[60:63], s58 offen lds
    ds_read_b64_tr_b16 v[68:69], v9 offset:5120
    ds_read_b64_tr_b16 v[70:71], v9 offset:5376
    s_waitcnt lgkmcnt(8)
    v_mfma_f32_32x32x16_bf16 v[32:47], v[72:75], v[136:139], v[32:47]
    v_mul_f32 v80, v48, v104
    v_mul_f32 v81, v49, v104
    v_mul_f32 v82, v50, v104
    ds_read_b64_tr_b16 v[72:73], v9 offset:6144
    ds_read_b64_tr_b16 v[74:75], v9 offset:6400
    s_waitcnt lgkmcnt(6)
    v_mfma_f32_32x32x16_bf16 v[32:47], v[76:79], v[140:143], v[32:47]
    v_mul_f32 v83, v51, v104
    v_mul_f32 v84, v52, v104
    v_mul_f32 v85, v53, v104
    ds_read_b64_tr_b16 v[76:77], v9 offset:7168
    ds_read_b64_tr_b16 v[78:79], v9 offset:7424
    s_waitcnt lgkmcnt(6)
    v_mfma_f32_32x32x16_bf16 v[32:47], v[64:67], v[144:147], v[32:47]
    s_and_b32 s65, s40, 1
    s_lshl_b32 s65, s65, 2
    s_add_u32 m0, s96, 16384
    s_add_u32 s47, s95, 0x400000
    buffer_load_dwordx4 v2, s[36:39], s47 offen sc1 lds
    buffer_load_dwordx4 v2, s[36:39], s47 offen offset:1024 sc1 lds
    v_mul_f32 v86, v54, v104
    v_mul_f32 v87, v55, v104
    v_exp_f32 v80, v80
    ds_read_b64_tr_b16 v[64:65], v9 offset:8192
    ds_read_b64_tr_b16 v[66:67], v9 offset:8448
    s_waitcnt lgkmcnt(6)
    v_mfma_f32_32x32x16_bf16 v[32:47], v[68:71], v[148:151], v[32:47]
    s_lshr_b32 s66, s40, 1
    s_add_u32 s65, s65, s66
    v_exp_f32 v81, v81
    v_exp_f32 v82, v82
    v_exp_f32 v83, v83
    ds_read_b64_tr_b16 v[68:69], v9 offset:9216
    ds_read_b64_tr_b16 v[70:71], v9 offset:9472
    s_waitcnt lgkmcnt(6)
    v_mfma_f32_32x32x16_bf16 v[32:47], v[72:75], v[152:155], v[32:47]
    s_lshl_b32 s65, s65, 13
    v_bfe_u32 v21, v2, 4, 5
    v_exp_f32 v84, v84
    v_exp_f32 v85, v85
    v_exp_f32 v86, v86
    ds_read_b64_tr_b16 v[72:73], v9 offset:10240
    ds_read_b64_tr_b16 v[74:75], v9 offset:10496
    s_waitcnt lgkmcnt(6)
    v_mfma_f32_32x32x16_bf16 v[32:47], v[76:79], v[156:159], v[32:47]
    v_lshrrev_b32 v20, 9, v2
    v_add_u32 v12, 0, v20
    v_exp_f32 v87, v87
    v_mul_f32 v56, v48, v56
    v_mul_f32 v57, v49, v57
    ds_read_b64_tr_b16 v[76:77], v9 offset:11264
    ds_read_b64_tr_b16 v[78:79], v9 offset:11520
    s_waitcnt lgkmcnt(6)
    v_mfma_f32_32x32x16_bf16 v[32:47], v[64:67], v[160:163], v[32:47]
    v_xor_b32 v12, v12, v21
    v_and_b32 v12, 7, v12
    v_mul_f32 v58, v50, v58
    v_mul_f32 v59, v51, v59
    v_mul_f32 v60, v52, v60
    ds_read_b64_tr_b16 v[64:65], v9 offset:12288
    ds_read_b64_tr_b16 v[66:67], v9 offset:12544
    s_waitcnt lgkmcnt(6)
    v_mfma_f32_32x32x16_bf16 v[32:47], v[68:71], v[164:167], v[32:47]
    v_lshlrev_b32 v12, 4, v12
    v_lshl_add_u32 v12, v21, 8, v12
    v_mul_f32 v61, v53, v61
    v_mul_f32 v62, v54, v62
    v_mul_f32 v63, v55, v63
    ds_read_b64_tr_b16 v[68:69], v9 offset:13312
    ds_read_b64_tr_b16 v[70:71], v9 offset:13568
    s_waitcnt lgkmcnt(6)
    v_mfma_f32_32x32x16_bf16 v[32:47], v[72:75], v[168:171], v[32:47]
    v_add_u32 v12, s65, v12
    v_add_u32 v13, 2, v20
    v_fma_f32 v80, v80, v105, v105
    v_fma_f32 v81, v81, v105, v105
    v_fma_f32 v82, v82, v105, v105
    ds_read_b64_tr_b16 v[72:73], v9 offset:14336
    ds_read_b64_tr_b16 v[74:75], v9 offset:14592
    s_waitcnt lgkmcnt(6)
    v_mfma_f32_32x32x16_bf16 v[32:47], v[76:79], v[172:175], v[32:47]
    v_xor_b32 v13, v13, v21
    v_and_b32 v13, 7, v13
    v_fma_f32 v83, v83, v105, v105
    v_fma_f32 v84, v84, v105, v105
    v_fma_f32 v85, v85, v105, v105
    ds_read_b64_tr_b16 v[76:77], v9 offset:15360
    ds_read_b64_tr_b16 v[78:79], v9 offset:15616
    s_waitcnt lgkmcnt(6)
    v_mfma_f32_32x32x16_bf16 v[32:47], v[64:67], v[176:179], v[32:47]
    v_lshlrev_b32 v13, 4, v13
    v_lshl_add_u32 v13, v21, 8, v13
    v_fma_f32 v86, v86, v105, v105
    v_fma_f32 v87, v87, v105, v105
    v_rcp_f32 v80, v80
    s_waitcnt vmcnt(8)
    s_barrier
    v_add_u32 v9, 98304, v8
    ds_read_b64_tr_b16 v[64:65], v9 offset:0
    ds_read_b64_tr_b16 v[66:67], v9 offset:256
    s_waitcnt lgkmcnt(6)
    v_mfma_f32_32x32x16_bf16 v[32:47], v[68:71], v[180:183], v[32:47]
    v_add_u32 v13, s65, v13
    v_add_u32 v14, 4, v20
    v_rcp_f32 v81, v81
    v_rcp_f32 v82, v82
    v_rcp_f32 v83, v83
    ds_read_b64_tr_b16 v[68:69], v9 offset:1024
    ds_read_b64_tr_b16 v[70:71], v9 offset:1280
    s_waitcnt lgkmcnt(6)
    v_mfma_f32_32x32x16_bf16 v[32:47], v[72:75], v[184:187], v[32:47]
    v_xor_b32 v14, v14, v21
    v_and_b32 v14, 7, v14
    v_rcp_f32 v84, v84
    v_rcp_f32 v85, v85
    v_rcp_f32 v86, v86
    ds_read_b64_tr_b16 v[72:73], v9 offset:2048
    ds_read_b64_tr_b16 v[74:75], v9 offset:2304
    s_waitcnt lgkmcnt(6)
    v_mfma_f32_32x32x16_bf16 v[32:47], v[76:79], v[188:191], v[32:47]
    v_lshlrev_b32 v14, 4, v14
    v_lshl_add_u32 v14, v21, 8, v14
    v_rcp_f32 v87, v87
    v_mul_f32 v56, v56, v80
    v_mul_f32 v57, v57, v81
    ds_read_b64_tr_b16 v[76:77], v9 offset:3072
    ds_read_b64_tr_b16 v[78:79], v9 offset:3328
    s_waitcnt lgkmcnt(6)
    v_mfma_f32_32x32x16_bf16 v[32:47], v[64:67], v[192:195], v[32:47]
    v_add_u32 v14, s65, v14
    v_add_u32 v15, 6, v20
    v_mul_f32 v58, v58, v82
    v_mul_f32 v59, v59, v83
    v_mul_f32 v60, v60, v84
    ds_read_b64_tr_b16 v[64:65], v9 offset:4096
    ds_read_b64_tr_b16 v[66:67], v9 offset:4352
    s_waitcnt lgkmcnt(6)
    v_mfma_f32_32x32x16_bf16 v[32:47], v[68:71], v[196:199], v[32:47]
    v_xor_b32 v15, v15, v21
    v_and_b32 v15, 7, v15
    v_mul_f32 v61, v61, v85
    v_mul_f32 v62, v62, v86
    v_mul_f32 v63, v63, v87
    ds_read_b64_tr_b16 v[68:69], v9 offset:5120
    ds_read_b64_tr_b16 v[70:71], v9 offset:5376
    s_waitcnt lgkmcnt(6)
    v_mfma_f32_32x32x16_bf16 v[32:47], v[72:75], v[200:203], v[32:47]
    v_lshlrev_b32 v15, 4, v15
    v_lshl_add_u32 v15, v21, 8, v15
    v_cvt_pk_bf16_f32 v88, v56, v57
    v_cvt_pk_bf16_f32 v89, v58, v59
    v_cvt_pk_bf16_f32 v90, v60, v61
    ds_read_b64_tr_b16 v[72:73], v9 offset:6144
    ds_read_b64_tr_b16 v[74:75], v9 offset:6400
    s_waitcnt lgkmcnt(6)
    v_mfma_f32_32x32x16_bf16 v[32:47], v[76:79], v[204:207], v[32:47]
    v_add_u32 v15, s65, v15
    s_lshr_b32 s65, s40, 2
    v_cvt_pk_bf16_f32 v91, v62, v63
    ds_read_b64_tr_b16 v[76:77], v9 offset:7168
    ds_read_b64_tr_b16 v[78:79], v9 offset:7424
    s_waitcnt lgkmcnt(6)
    v_mfma_f32_32x32x16_bf16 v[32:47], v[64:67], v[208:211], v[32:47]
    s_lshl_b32 s65, s65, 15
    s_and_b32 s66, s40, 3
    ds_read_b64_tr_b16 v[64:65], v9 offset:8192
    ds_read_b64_tr_b16 v[66:67], v9 offset:8448
    s_waitcnt lgkmcnt(6)
    v_mfma_f32_32x32x16_bf16 v[32:47], v[68:71], v[212:215], v[32:47]
    s_lshl_b32 s66, s66, 11
    s_add_u32 s65, s65, s66
    ds_read_b64_tr_b16 v[68:69], v9 offset:9216
    ds_read_b64_tr_b16 v[70:71], v9 offset:9472
    s_waitcnt lgkmcnt(6)
    v_mfma_f32_32x32x16_bf16 v[32:47], v[72:75], v[216:219], v[32:47]
    v_lshrrev_b32 v20, 7, v2
    v_bfe_u32 v21, v2, 4, 3
    ds_read_b64_tr_b16 v[72:73], v9 offset:10240
    ds_read_b64_tr_b16 v[74:75], v9 offset:10496
    s_waitcnt lgkmcnt(6)
    v_mfma_f32_32x32x16_bf16 v[32:47], v[76:79], v[220:223], v[32:47]
    v_lshlrev_b32 v21, 1, v21
    v_xor_b32 v21, v21, v20
    ds_read_b64_tr_b16 v[76:77], v9 offset:11264
    ds_read_b64_tr_b16 v[78:79], v9 offset:11520
    s_waitcnt lgkmcnt(6)
    v_mfma_f32_32x32x16_bf16 v[32:47], v[64:67], v[224:227], v[32:47]
    v_lshlrev_b32 v21, 4, v21
    v_lshl_add_u32 v20, v20, 8, v21
    ds_read_b64_tr_b16 v[64:65], v9 offset:12288
    ds_read_b64_tr_b16 v[66:67], v9 offset:12544
    s_waitcnt lgkmcnt(6)
    v_mfma_f32_32x32x16_bf16 v[32:47], v[68:71], v[228:231], v[32:47]
    v_add_u32 v20, s65, v20
    v_xor_b32 v21, 16, v20
    ds_read_b64_tr_b16 v[68:69], v9 offset:13312
    ds_read_b64_tr_b16 v[70:71], v9 offset:13568
    s_waitcnt lgkmcnt(6)
    v_mfma_f32_32x32x16_bf16 v[32:47], v[72:75], v[232:235], v[32:47]
    v_lshrrev_b32 v24, 7, v2
    v_bfe_u32 v25, v2, 4, 3
    ds_read_b64_tr_b16 v[72:73], v9 offset:14336
    ds_read_b64_tr_b16 v[74:75], v9 offset:14592
    s_waitcnt lgkmcnt(6)
    v_mfma_f32_32x32x16_bf16 v[32:47], v[76:79], v[236:239], v[32:47]
    v_lshlrev_b32 v24, 10, v24
    v_lshl_add_u32 v11, v25, 4, v24
    ds_read_b64_tr_b16 v[76:77], v9 offset:15360
    ds_read_b64_tr_b16 v[78:79], v9 offset:15616
    s_waitcnt lgkmcnt(6)
    v_mfma_f32_32x32x16_bf16 v[32:47], v[64:67], v[240:243], v[32:47]
    s_waitcnt vmcnt(2)
    v_bfe_u32 v26, v2, 6, 2
    v_lshrrev_b32 v27, 9, v2
    v_lshl_add_u32 v26, v27, 2, v26
    v_lshlrev_b32 v26, 6, v26
    v_bfe_u32 v27, v2, 4, 2
    v_lshl_add_u32 v26, v27, 3, v26
    v_bfe_u32 v27, v2, 8, 1
    v_lshl_add_u32 v26, v27, 5, v26
    s_lshl_b32 s66, s40, 11
    s_add_u32 s66, s66, 139264
    v_add_u32 v26, s66, v26
    ds_read_b64_tr_b16 v[176:177], v26 offset:0
    ds_read_b64_tr_b16 v[178:179], v26 offset:512
    ds_read_b64_tr_b16 v[180:181], v26 offset:1024
    ds_read_b64_tr_b16 v[182:183], v26 offset:1536
    s_waitcnt lgkmcnt(8)
    v_mfma_f32_32x32x16_bf16 v[32:47], v[68:71], v[244:247], v[32:47]
    s_add_u32 s67, s51, 2048
    buffer_store_dwordx4 v[88:91], v2, s[36:39], s67 offen sc1
    s_waitcnt lgkmcnt(6)
    v_mfma_f32_32x32x16_bf16 v[32:47], v[72:75], v[248:251], v[32:47]
    s_waitcnt lgkmcnt(4)
    v_mfma_f32_32x32x16_bf16 v[32:47], v[76:79], v[252:255], v[32:47]
    s_waitcnt lgkmcnt(0)
    buffer_store_dwordx4 v[176:179], v2, s[36:39], s57 offen sc1
    buffer_store_dwordx4 v[180:183], v2, s[36:39], s64 offen sc1
    s_waitcnt vmcnt(3)
    s_barrier
    ds_read_b128 v[116:119], v2
    ds_read_b128 v[120:123], v3
    ds_read_b128 v[124:127], v3 offset:512
    v_mov_b32 v160, 0
    v_mov_b32 v161, 0
    v_mov_b32 v162, 0
    v_mov_b32 v163, 0
    v_mov_b32 v164, 0
    v_mov_b32 v165, 0
    v_mov_b32 v166, 0
    v_mov_b32 v167, 0
    v_mov_b32 v168, 0
    v_mov_b32 v169, 0
    v_mov_b32 v170, 0
    v_mov_b32 v171, 0
    v_mov_b32 v172, 0
    v_mov_b32 v173, 0
    v_mov_b32 v174, 0
    v_mov_b32 v175, 0
    v_mov_b32 v7, 0xdddddddd
    s_waitcnt lgkmcnt(2)
    v_mfma_f32_32x32x16_bf16 v[128:143], v[116:119], v[112:115], 0
    ds_read_b128 v[116:119], v2 offset:1024
    s_add_u32 m0, s96, 32768
    s_add_u32 s47, s95, 0x204000
    buffer_load_dwordx4 v2, s[36:39], s47 offen sc1 lds
    buffer_load_dwordx4 v2, s[36:39], s47 offen offset:1024 sc1 lds
    s_add_u32 m0, s96, 49152
    s_add_u32 s47, s95, 0x404000
    buffer_load_dwordx4 v2, s[36:39], s47 offen sc1 lds
    buffer_load_dwordx4 v2, s[36:39], s47 offen offset:1024 sc1 lds
    v_mul_f32 v80, v32, v104
    v_mul_f32 v81, v33, v104
    v_mul_f32 v82, v34, v104
    v_mul_f32 v83, v35, v104
    v_mul_f32 v84, v36, v104
    v_mul_f32 v85, v37, v104
    v_mul_f32 v86, v38, v104
    v_mul_f32 v87, v39, v104
    v_exp_f32 v80, v80
    v_exp_f32 v81, v81
    v_exp_f32 v82, v82
    v_exp_f32 v83, v83
    v_exp_f32 v84, v84
    v_exp_f32 v85, v85
    v_exp_f32 v86, v86
    v_exp_f32 v87, v87
    v_mul_f32 v40, v32, v40
    v_mul_f32 v41, v33, v41
    v_mul_f32 v42, v34, v42
    v_mul_f32 v43, v35, v43
    v_mul_f32 v44, v36, v44
    v_mul_f32 v45, v37, v45
    v_mul_f32 v46, v38, v46
    v_mul_f32 v47, v39, v47
    v_fma_f32 v80, v80, v105, v105
    v_fma_f32 v81, v81, v105, v105
    v_fma_f32 v82, v82, v105, v105
    v_fma_f32 v83, v83, v105, v105
    v_fma_f32 v84, v84, v105, v105
    v_fma_f32 v85, v85, v105, v105
    v_fma_f32 v86, v86, v105, v105
    v_fma_f32 v87, v87, v105, v105
    v_rcp_f32 v80, v80
    v_rcp_f32 v81, v81
    v_rcp_f32 v82, v82
    v_rcp_f32 v83, v83
    v_rcp_f32 v84, v84
    v_rcp_f32 v85, v85
    v_rcp_f32 v86, v86
    v_rcp_f32 v87, v87
    v_mul_f32 v40, v40, v80
    v_mul_f32 v41, v41, v81
    v_mul_f32 v42, v42, v82
    v_mul_f32 v43, v43, v83
    v_mul_f32 v44, v44, v84
    v_mul_f32 v45, v45, v85
    v_mul_f32 v46, v46, v86
    v_mul_f32 v47, v47, v87
    v_cvt_pk_bf16_f32 v88, v40, v41
    v_cvt_pk_bf16_f32 v89, v42, v43
    v_cvt_pk_bf16_f32 v90, v44, v45
    v_cvt_pk_bf16_f32 v91, v46, v47
    s_add_u32 s67, s51, 4096
    buffer_store_dwordx4 v[88:91], v2, s[36:39], s67 offen sc1
    s_branch L_attn
L_typeA:
    v_add_u32 v9, 131072, v7
    ds_read_b64_tr_b16 v[64:65], v9 offset:0
    ds_read_b64_tr_b16 v[66:67], v9 offset:256
    ds_read_b64_tr_b16 v[68:69], v9 offset:1024
    ds_read_b64_tr_b16 v[70:71], v9 offset:1280
    ds_read_b64_tr_b16 v[72:73], v9 offset:2048
    ds_read_b64_tr_b16 v[74:75], v9 offset:2304
    ds_read_b64_tr_b16 v[76:77], v9 offset:3072
    ds_read_b64_tr_b16 v[78:79], v9 offset:3328
    s_waitcnt lgkmcnt(6)
    v_mfma_f32_32x32x16_bf16 v[32:47], v[128:131], v[64:67], 0
    s_add_u32 m0, s44, 0
    s_add_u32 s47, s45, 788480
    buffer_load_dwordx4 v5, s[24:27], s47 offen lds
    ds_read_b128 v[192:195], v10 offset:0
    ds_read_b64_tr_b16 v[64:65], v9 offset:4096
    ds_read_b64_tr_b16 v[66:67], v9 offset:4352
    s_waitcnt lgkmcnt(7)
    v_mfma_f32_32x32x16_bf16 v[32:47], v[132:135], v[68:71], v[32:47]
    s_add_u32 m0, s44, 1024
    s_add_u32 s48, s45, 837632
    buffer_load_dwordx4 v5, s[24:27], s48 offen lds
    ds_read_b128 v[196:199], v11 offset:0
    ds_read_b64_tr_b16 v[68:69], v9 offset:5120
    ds_read_b64_tr_b16 v[70:71], v9 offset:5376
    s_waitcnt lgkmcnt(8)
    v_mfma_f32_32x32x16_bf16 v[32:47], v[136:139], v[72:75], v[32:47]
    s_add_u32 m0, s44, 2048
    s_add_u32 s47, s45, 886784
    buffer_load_dwordx4 v5, s[24:27], s47 offen lds
    ds_read_b128 v[200:203], v12 offset:0
    ds_read_b64_tr_b16 v[72:73], v9 offset:6144
    ds_read_b64_tr_b16 v[74:75], v9 offset:6400
    s_waitcnt lgkmcnt(9)
    v_mfma_f32_32x32x16_bf16 v[32:47], v[140:143], v[76:79], v[32:47]
    s_add_u32 m0, s44, 3072
    s_add_u32 s48, s45, 935936
    buffer_load_dwordx4 v5, s[24:27], s48 offen lds
    ds_read_b128 v[204:207], v13 offset:0
    ds_read_b64_tr_b16 v[76:77], v9 offset:7168
    ds_read_b64_tr_b16 v[78:79], v9 offset:7424
    s_waitcnt lgkmcnt(9)
    v_mfma_f32_32x32x16_bf16 v[32:47], v[144:147], v[64:67], v[32:47]
    ds_read_b128 v[208:211], v10 offset:4096
    ds_read_b128 v[212:215], v11 offset:4096
    ds_read_b64_tr_b16 v[64:65], v9 offset:8192
    ds_read_b64_tr_b16 v[66:67], v9 offset:8448
    s_waitcnt lgkmcnt(10)
    v_mfma_f32_32x32x16_bf16 v[32:47], v[148:151], v[68:71], v[32:47]
    ds_read_b128 v[216:219], v12 offset:4096
    ds_read_b64_tr_b16 v[68:69], v9 offset:9216
    ds_read_b64_tr_b16 v[70:71], v9 offset:9472
    s_waitcnt lgkmcnt(10)
    v_mfma_f32_32x32x16_bf16 v[32:47], v[152:155], v[72:75], v[32:47]
    s_add_u32 m0, s44, 32768
    s_add_u32 s47, s46, 0
    buffer_load_dwordx4 v6, s[28:31], s47 offen lds
    ds_read_b128 v[220:223], v13 offset:4096
    ds_read_b64_tr_b16 v[72:73], v9 offset:10240
    ds_read_b64_tr_b16 v[74:75], v9 offset:10496
    s_waitcnt lgkmcnt(10)
    v_mfma_f32_32x32x16_bf16 v[32:47], v[156:159], v[76:79], v[32:47]
    ds_read_b128 v[224:227], v10 offset:8192
    ds_read_b64_tr_b16 v[76:77], v9 offset:11264
    ds_read_b64_tr_b16 v[78:79], v9 offset:11520
    s_waitcnt lgkmcnt(9)
    v_mfma_f32_32x32x16_bf16 v[32:47], v[160:163], v[64:67], v[32:47]
    s_add_u32 m0, s44, 33792
    s_add_u32 s48, s46, 57344
    buffer_load_dwordx4 v6, s[28:31], s48 offen lds
    ds_read_b128 v[228:231], v11 offset:8192
    ds_read_b128 v[232:235], v12 offset:8192
    ds_read_b64_tr_b16 v[64:65], v9 offset:12288
    ds_read_b64_tr_b16 v[66:67], v9 offset:12544
    s_waitcnt lgkmcnt(10)
    v_mfma_f32_32x32x16_bf16 v[32:47], v[164:167], v[68:71], v[32:47]
    ds_read_b128 v[236:239], v13 offset:8192
    ds_read_b64_tr_b16 v[68:69], v9 offset:13312
    ds_read_b64_tr_b16 v[70:71], v9 offset:13568
    s_waitcnt lgkmcnt(10)
    v_mfma_f32_32x32x16_bf16 v[32:47], v[168:171], v[72:75], v[32:47]
    s_add_u32 m0, s44, 34816
    s_add_u32 s47, s46, 114688
    buffer_load_dwordx4 v6, s[28:31], s47 offen lds
    ds_read_b128 v[240:243], v10 offset:12288
    ds_read_b64_tr_b16 v[72:73], v9 offset:14336
    ds_read_b64_tr_b16 v[74:75], v9 offset:14592
    s_waitcnt lgkmcnt(10)
    v_mfma_f32_32x32x16_bf16 v[32:47], v[172:175], v[76:79], v[32:47]
    ds_read_b128 v[244:247], v11 offset:12288
    ds_read_b64_tr_b16 v[76:77], v9 offset:15360
    ds_read_b64_tr_b16 v[78:79], v9 offset:15616
    s_waitcnt lgkmcnt(9)
    v_mfma_f32_32x32x16_bf16 v[32:47], v[176:179], v[64:67], v[32:47]
    s_add_u32 m0, s44, 35840
    s_add_u32 s48, s46, 172032
    buffer_load_dwordx4 v6, s[28:31], s48 offen lds
    ds_read_b128 v[248:251], v12 offset:12288
    ds_read_b128 v[252:255], v13 offset:12288
    s_waitcnt vmcnt(4)
    s_waitcnt lgkmcnt(0)
    s_barrier
    v_add_u32 v9, 0, v7
    s_lshl_b32 s65, s2, 9
    s_and_b32 s66, s40, 3
    s_lshl_b32 s66, s66, 7
    s_add_u32 s65, s65, s66
    s_add_u32 s65, s65, 0xc00000
    v_bfe_u32 v26, v2, 4, 5
    v_lshlrev_b32 v26, 2, v26
    buffer_load_dword v16, v26, s[36:39], s65 offen
    v_lshrrev_b32 v27, 9, v2
    v_lshlrev_b32 v27, 4, v27
    buffer_load_dwordx4 v[112:115], v27, s[36:39], s65 offen offset:0
    buffer_load_dwordx4 v[116:119], v27, s[36:39], s65 offen offset:32
    buffer_load_dwordx4 v[120:123], v27, s[36:39], s65 offen offset:64
    buffer_load_dwordx4 v[124:127], v27, s[36:39], s65 offen offset:96
    ds_read_b64_tr_b16 v[64:65], v9 offset:0
    ds_read_b64_tr_b16 v[66:67], v9 offset:256
    v_mfma_f32_32x32x16_bf16 v[32:47], v[180:183], v[68:71], v[32:47]
    v_mov_b32 v28, 0
    buffer_store_dword v28, v31, s[36:39], s97 offen sc1
    v_mov_b32 v24, -1
    v_mov_b32 v25, -1
    v_mov_b32 v26, -1
    v_mov_b32 v27, -1
    buffer_store_dwordx4 v[24:27], v2, s[36:39], s99 offen sc1
    ds_read_b64_tr_b16 v[68:69], v9 offset:1024
    ds_read_b64_tr_b16 v[70:71], v9 offset:1280
    v_mfma_f32_32x32x16_bf16 v[32:47], v[184:187], v[72:75], v[32:47]
    ds_read_b64_tr_b16 v[72:73], v9 offset:2048
    ds_read_b64_tr_b16 v[74:75], v9 offset:2304
    v_mfma_f32_32x32x16_bf16 v[32:47], v[188:191], v[76:79], v[32:47]
    ds_read_b64_tr_b16 v[76:77], v9 offset:3072
    ds_read_b64_tr_b16 v[78:79], v9 offset:3328
    s_waitcnt lgkmcnt(6)
    v_mfma_f32_32x32x16_bf16 v[32:47], v[192:195], v[64:67], v[32:47]
    s_add_u32 m0, s44, 65536
    s_add_u32 s47, s46, 917504
    buffer_load_dwordx4 v6, s[28:31], s47 offen lds
    ds_read_b64_tr_b16 v[64:65], v9 offset:4096
    ds_read_b64_tr_b16 v[66:67], v9 offset:4352
    s_waitcnt lgkmcnt(6)
    v_mfma_f32_32x32x16_bf16 v[32:47], v[196:199], v[68:71], v[32:47]
    ds_read_b64_tr_b16 v[68:69], v9 offset:5120
    ds_read_b64_tr_b16 v[70:71], v9 offset:5376
    s_waitcnt lgkmcnt(6)
    v_mfma_f32_32x32x16_bf16 v[32:47], v[200:203], v[72:75], v[32:47]
    ds_read_b64_tr_b16 v[72:73], v9 offset:6144
    ds_read_b64_tr_b16 v[74:75], v9 offset:6400
    s_waitcnt lgkmcnt(6)
    v_mfma_f32_32x32x16_bf16 v[32:47], v[204:207], v[76:79], v[32:47]
    ds_read_b64_tr_b16 v[76:77], v9 offset:7168
    ds_read_b64_tr_b16 v[78:79], v9 offset:7424
    s_waitcnt lgkmcnt(6)
    v_mfma_f32_32x32x16_bf16 v[32:47], v[208:211], v[64:67], v[32:47]
    s_add_u32 m0, s44, 66560
    s_add_u32 s48, s46, 974848
    buffer_load_dwordx4 v6, s[28:31], s48 offen lds
    ds_read_b64_tr_b16 v[64:65], v9 offset:8192
    ds_read_b64_tr_b16 v[66:67], v9 offset:8448
    s_waitcnt lgkmcnt(6)
    v_mfma_f32_32x32x16_bf16 v[32:47], v[212:215], v[68:71], v[32:47]
    ds_read_b64_tr_b16 v[68:69], v9 offset:9216
    ds_read_b64_tr_b16 v[70:71], v9 offset:9472
    s_waitcnt lgkmcnt(6)
    v_mfma_f32_32x32x16_bf16 v[32:47], v[216:219], v[72:75], v[32:47]
    ds_read_b64_tr_b16 v[72:73], v9 offset:10240
    ds_read_b64_tr_b16 v[74:75], v9 offset:10496
    s_waitcnt lgkmcnt(6)
    v_mfma_f32_32x32x16_bf16 v[32:47], v[220:223], v[76:79], v[32:47]
    ds_read_b64_tr_b16 v[76:77], v9 offset:11264
    ds_read_b64_tr_b16 v[78:79], v9 offset:11520
    s_waitcnt lgkmcnt(6)
    v_mfma_f32_32x32x16_bf16 v[32:47], v[224:227], v[64:67], v[32:47]
    s_add_u32 m0, s44, 67584
    s_add_u32 s47, s46, 1032192
    buffer_load_dwordx4 v6, s[28:31], s47 offen lds
    ds_read_b64_tr_b16 v[64:65], v9 offset:12288
    ds_read_b64_tr_b16 v[66:67], v9 offset:12544
    s_waitcnt lgkmcnt(6)
    v_mfma_f32_32x32x16_bf16 v[32:47], v[228:231], v[68:71], v[32:47]
    ds_read_b64_tr_b16 v[68:69], v9 offset:13312
    ds_read_b64_tr_b16 v[70:71], v9 offset:13568
    s_waitcnt lgkmcnt(6)
    v_mfma_f32_32x32x16_bf16 v[32:47], v[232:235], v[72:75], v[32:47]
    ds_read_b64_tr_b16 v[72:73], v9 offset:14336
    ds_read_b64_tr_b16 v[74:75], v9 offset:14592
    s_waitcnt lgkmcnt(6)
    v_mfma_f32_32x32x16_bf16 v[32:47], v[236:239], v[76:79], v[32:47]
    ds_read_b64_tr_b16 v[76:77], v9 offset:15360
    ds_read_b64_tr_b16 v[78:79], v9 offset:15616
    s_waitcnt lgkmcnt(6)
    v_mfma_f32_32x32x16_bf16 v[32:47], v[240:243], v[64:67], v[32:47]
    s_add_u32 m0, s44, 68608
    s_add_u32 s48, s46, 1089536
    buffer_load_dwordx4 v6, s[28:31], s48 offen lds
    s_waitcnt vmcnt(11)
    s_barrier
    v_add_u32 v9, 32768, v8
    s_waitcnt vmcnt(6)
    v_mul_f32 v105, v16, v16
    v_mul_f32 v104, 0xbfb8aa3b, v16
    v_mul_f32 v19, 0x3eb8aa3b, v16
    v_rcp_f32 v105, v105
    ds_read_b64_tr_b16 v[64:65], v9 offset:0
    ds_read_b64_tr_b16 v[66:67], v9 offset:256
    s_waitcnt lgkmcnt(6)
    v_mfma_f32_32x32x16_bf16 v[32:47], v[244:247], v[68:71], v[32:47]
    ds_read_b64_tr_b16 v[68:69], v9 offset:1024
    ds_read_b64_tr_b16 v[70:71], v9 offset:1280
    s_waitcnt lgkmcnt(6)
    v_mfma_f32_32x32x16_bf16 v[32:47], v[248:251], v[72:75], v[32:47]
    ds_read_b64_tr_b16 v[72:73], v9 offset:2048
    ds_read_b64_tr_b16 v[74:75], v9 offset:2304
    s_waitcnt lgkmcnt(6)
    v_mfma_f32_32x32x16_bf16 v[32:47], v[252:255], v[76:79], v[32:47]
    ds_read_b64_tr_b16 v[76:77], v9 offset:3072
    ds_read_b64_tr_b16 v[78:79], v9 offset:3328
    s_waitcnt lgkmcnt(6)
    v_mfma_f32_32x32x16_bf16 v[48:63], v[64:67], v[128:131], 0
    s_add_u32 m0, s44, 98304
    s_add_u32 s47, s46, 64
    buffer_load_dwordx4 v6, s[28:31], s47 offen lds
    ds_read_b64_tr_b16 v[64:65], v9 offset:4096
    ds_read_b64_tr_b16 v[66:67], v9 offset:4352
    s_waitcnt lgkmcnt(6)
    v_mfma_f32_32x32x16_bf16 v[48:63], v[68:71], v[132:135], v[48:63]
    ds_read_b64_tr_b16 v[68:69], v9 offset:5120
    ds_read_b64_tr_b16 v[70:71], v9 offset:5376
    s_waitcnt lgkmcnt(6)
    v_mfma_f32_32x32x16_bf16 v[48:63], v[72:75], v[136:139], v[48:63]
    v_mul_f32 v32, v32, v112
    v_mul_f32 v33, v33, v113
    v_mul_f32 v34, v34, v114
    ds_read_b64_tr_b16 v[72:73], v9 offset:6144
    ds_read_b64_tr_b16 v[74:75], v9 offset:6400
    s_waitcnt lgkmcnt(6)
    v_mfma_f32_32x32x16_bf16 v[48:63], v[76:79], v[140:143], v[48:63]
    v_mul_f32 v35, v35, v115
    v_mul_f32 v36, v36, v116
    v_mul_f32 v37, v37, v117
    ds_read_b64_tr_b16 v[76:77], v9 offset:7168
    ds_read_b64_tr_b16 v[78:79], v9 offset:7424
    s_waitcnt lgkmcnt(6)
    v_mfma_f32_32x32x16_bf16 v[48:63], v[64:67], v[144:147], v[48:63]
    s_add_u32 m0, s44, 99328
    s_add_u32 s48, s46, 57408
    buffer_load_dwordx4 v6, s[28:31], s48 offen lds
    v_mul_f32 v38, v38, v118
    v_mul_f32 v39, v39, v119
    v_mul_f32 v40, v40, v120
    ds_read_b64_tr_b16 v[64:65], v9 offset:8192
    ds_read_b64_tr_b16 v[66:67], v9 offset:8448
    s_waitcnt lgkmcnt(6)
    v_mfma_f32_32x32x16_bf16 v[48:63], v[68:71], v[148:151], v[48:63]
    v_mul_f32 v41, v41, v121
    v_mul_f32 v42, v42, v122
    v_mul_f32 v43, v43, v123
    ds_read_b64_tr_b16 v[68:69], v9 offset:9216
    ds_read_b64_tr_b16 v[70:71], v9 offset:9472
    s_waitcnt lgkmcnt(6)
    v_mfma_f32_32x32x16_bf16 v[48:63], v[72:75], v[152:155], v[48:63]
    v_mul_f32 v44, v44, v124
    v_mul_f32 v45, v45, v125
    v_mul_f32 v46, v46, v126
    ds_read_b64_tr_b16 v[72:73], v9 offset:10240
    ds_read_b64_tr_b16 v[74:75], v9 offset:10496
    s_waitcnt lgkmcnt(6)
    v_mfma_f32_32x32x16_bf16 v[48:63], v[76:79], v[156:159], v[48:63]
    v_mul_f32 v47, v47, v127
    v_cvt_pk_bf16_f32 v80, v32, v33
    v_cvt_pk_bf16_f32 v81, v34, v35
    ds_read_b64_tr_b16 v[76:77], v9 offset:11264
    ds_read_b64_tr_b16 v[78:79], v9 offset:11520
    s_waitcnt lgkmcnt(6)
    v_mfma_f32_32x32x16_bf16 v[48:63], v[64:67], v[160:163], v[48:63]
    s_add_u32 m0, s44, 100352
    s_add_u32 s47, s46, 114752
    buffer_load_dwordx4 v6, s[28:31], s47 offen lds
    v_cvt_pk_bf16_f32 v82, v36, v37
    v_cvt_pk_bf16_f32 v83, v38, v39
    v_cvt_pk_bf16_f32 v84, v40, v41
    ds_read_b64_tr_b16 v[64:65], v9 offset:12288
    ds_read_b64_tr_b16 v[66:67], v9 offset:12544
    s_waitcnt lgkmcnt(6)
    v_mfma_f32_32x32x16_bf16 v[48:63], v[68:71], v[164:167], v[48:63]
    v_cvt_pk_bf16_f32 v85, v42, v43
    v_cvt_pk_bf16_f32 v86, v44, v45
    v_cvt_pk_bf16_f32 v87, v46, v47
    buffer_store_dwordx4 v[80:83], v4, s[36:39], s50 offen sc1
    buffer_store_dwordx4 v[84:87], v4, s[36:39], s50 offen offset:512 sc1
    ds_read_b64_tr_b16 v[68:69], v9 offset:13312
    ds_read_b64_tr_b16 v[70:71], v9 offset:13568
    s_waitcnt lgkmcnt(6)
    v_mfma_f32_32x32x16_bf16 v[48:63], v[72:75], v[168:171], v[48:63]
    ds_read_b64_tr_b16 v[72:73], v9 offset:14336
    ds_read_b64_tr_b16 v[74:75], v9 offset:14592
    s_waitcnt lgkmcnt(6)
    v_mfma_f32_32x32x16_bf16 v[48:63], v[76:79], v[172:175], v[48:63]
    ds_read_b64_tr_b16 v[76:77], v9 offset:15360
    ds_read_b64_tr_b16 v[78:79], v9 offset:15616
    s_waitcnt lgkmcnt(6)
    v_mfma_f32_32x32x16_bf16 v[48:63], v[64:67], v[176:179], v[48:63]
    s_add_u32 m0, s44, 101376
    s_add_u32 s48, s46, 172096
    buffer_load_dwordx4 v6, s[28:31], s48 offen lds
    s_waitcnt vmcnt(6)
    s_barrier
    v_add_u32 v9, 65536, v8
    ds_read_b64_tr_b16 v[64:65], v9 offset:0
    ds_read_b64_tr_b16 v[66:67], v9 offset:256
    s_waitcnt lgkmcnt(6)
    v_mfma_f32_32x32x16_bf16 v[48:63], v[68:71], v[180:183], v[48:63]
    ds_read_b64_tr_b16 v[68:69], v9 offset:1024
    ds_read_b64_tr_b16 v[70:71], v9 offset:1280
    s_waitcnt lgkmcnt(6)
    v_mfma_f32_32x32x16_bf16 v[48:63], v[72:75], v[184:187], v[48:63]
    ds_read_b64_tr_b16 v[72:73], v9 offset:2048
    ds_read_b64_tr_b16 v[74:75], v9 offset:2304
    s_waitcnt lgkmcnt(6)
    v_mfma_f32_32x32x16_bf16 v[48:63], v[76:79], v[188:191], v[48:63]
    ds_read_b64_tr_b16 v[76:77], v9 offset:3072
    ds_read_b64_tr_b16 v[78:79], v9 offset:3328
    s_waitcnt lgkmcnt(6)
    v_mfma_f32_32x32x16_bf16 v[48:63], v[64:67], v[192:195], v[48:63]
    s_add_u32 m0, s44, 131072
    s_add_u32 s47, s46, 917568
    buffer_load_dwordx4 v6, s[28:31], s47 offen lds
    ds_read_b64_tr_b16 v[64:65], v9 offset:4096
    ds_read_b64_tr_b16 v[66:67], v9 offset:4352
    s_waitcnt lgkmcnt(6)
    v_mfma_f32_32x32x16_bf16 v[48:63], v[68:71], v[196:199], v[48:63]
    ds_read_b64_tr_b16 v[68:69], v9 offset:5120
    ds_read_b64_tr_b16 v[70:71], v9 offset:5376
    s_waitcnt lgkmcnt(6)
    v_mfma_f32_32x32x16_bf16 v[48:63], v[72:75], v[200:203], v[48:63]
    ds_read_b64_tr_b16 v[72:73], v9 offset:6144
    ds_read_b64_tr_b16 v[74:75], v9 offset:6400
    s_waitcnt lgkmcnt(6)
    v_mfma_f32_32x32x16_bf16 v[48:63], v[76:79], v[204:207], v[48:63]
    ds_read_b64_tr_b16 v[76:77], v9 offset:7168
    ds_read_b64_tr_b16 v[78:79], v9 offset:7424
    s_waitcnt lgkmcnt(6)
    v_mfma_f32_32x32x16_bf16 v[48:63], v[64:67], v[208:211], v[48:63]
    s_add_u32 m0, s44, 132096
    s_add_u32 s48, s46, 974912
    buffer_load_dwordx4 v6, s[28:31], s48 offen lds
    ds_read_b64_tr_b16 v[64:65], v9 offset:8192
    ds_read_b64_tr_b16 v[66:67], v9 offset:8448
    s_waitcnt lgkmcnt(6)
    v_mfma_f32_32x32x16_bf16 v[48:63], v[68:71], v[212:215], v[48:63]
    ds_read_b64_tr_b16 v[68:69], v9 offset:9216
    ds_read_b64_tr_b16 v[70:71], v9 offset:9472
    s_waitcnt lgkmcnt(6)
    v_mfma_f32_32x32x16_bf16 v[48:63], v[72:75], v[216:219], v[48:63]
    ds_read_b64_tr_b16 v[72:73], v9 offset:10240
    ds_read_b64_tr_b16 v[74:75], v9 offset:10496
    s_waitcnt lgkmcnt(6)
    v_mfma_f32_32x32x16_bf16 v[48:63], v[76:79], v[220:223], v[48:63]
    ds_read_b64_tr_b16 v[76:77], v9 offset:11264
    ds_read_b64_tr_b16 v[78:79], v9 offset:11520
    s_waitcnt lgkmcnt(6)
    v_mfma_f32_32x32x16_bf16 v[48:63], v[64:67], v[224:227], v[48:63]
    s_add_u32 m0, s44, 133120
    s_add_u32 s47, s46, 1032256
    buffer_load_dwordx4 v6, s[28:31], s47 offen lds
    ds_read_b64_tr_b16 v[64:65], v9 offset:12288
    ds_read_b64_tr_b16 v[66:67], v9 offset:12544
    s_waitcnt lgkmcnt(6)
    v_mfma_f32_32x32x16_bf16 v[48:63], v[68:71], v[228:231], v[48:63]
    ds_read_b64_tr_b16 v[68:69], v9 offset:13312
    ds_read_b64_tr_b16 v[70:71], v9 offset:13568
    s_waitcnt lgkmcnt(6)
    v_mfma_f32_32x32x16_bf16 v[48:63], v[72:75], v[232:235], v[48:63]
    ds_read_b64_tr_b16 v[72:73], v9 offset:14336
    ds_read_b64_tr_b16 v[74:75], v9 offset:14592
    s_waitcnt lgkmcnt(6)
    v_mfma_f32_32x32x16_bf16 v[48:63], v[76:79], v[236:239], v[48:63]
    ds_read_b64_tr_b16 v[76:77], v9 offset:15360
    ds_read_b64_tr_b16 v[78:79], v9 offset:15616
    s_waitcnt lgkmcnt(6)
    v_mfma_f32_32x32x16_bf16 v[48:63], v[64:67], v[240:243], v[48:63]
    s_add_u32 m0, s44, 134144
    s_add_u32 s48, s46, 1089600
    buffer_load_dwordx4 v6, s[28:31], s48 offen lds
    s_waitcnt vmcnt(4)
    s_barrier
    v_add_u32 v9, 98304, v8
    s_bfe_u32 s65, s2, 0x10003
    s_lshl_b32 s65, s65, 7
    v_mov_b32 v28, 1
    buffer_atomic_add v28, v31, s[68:71], s65 offen sc1
    ds_read_b64_tr_b16 v[64:65], v9 offset:0
    ds_read_b64_tr_b16 v[66:67], v9 offset:256
    s_waitcnt lgkmcnt(6)
    v_mfma_f32_32x32x16_bf16 v[48:63], v[68:71], v[244:247], v[48:63]
    ds_read_b64_tr_b16 v[68:69], v9 offset:1024
    ds_read_b64_tr_b16 v[70:71], v9 offset:1280
    s_waitcnt lgkmcnt(6)
    v_mfma_f32_32x32x16_bf16 v[48:63], v[72:75], v[248:251], v[48:63]
    ds_read_b64_tr_b16 v[72:73], v9 offset:2048
    ds_read_b64_tr_b16 v[74:75], v9 offset:2304
    s_waitcnt lgkmcnt(6)
    v_mfma_f32_32x32x16_bf16 v[48:63], v[76:79], v[252:255], v[48:63]
    ds_read_b64_tr_b16 v[76:77], v9 offset:3072
    ds_read_b64_tr_b16 v[78:79], v9 offset:3328
    s_waitcnt lgkmcnt(6)
    v_mfma_f32_32x32x16_bf16 v[32:47], v[64:67], v[128:131], 0
    s_add_u32 m0, s44, 0
    s_add_u32 s47, s46, 128
    buffer_load_dwordx4 v6, s[28:31], s47 offen lds
    ds_read_b64_tr_b16 v[64:65], v9 offset:4096
    ds_read_b64_tr_b16 v[66:67], v9 offset:4352
    s_waitcnt lgkmcnt(6)
    v_mfma_f32_32x32x16_bf16 v[32:47], v[68:71], v[132:135], v[32:47]
    ds_read_b64_tr_b16 v[68:69], v9 offset:5120
    ds_read_b64_tr_b16 v[70:71], v9 offset:5376
    s_waitcnt lgkmcnt(6)
    v_mfma_f32_32x32x16_bf16 v[32:47], v[72:75], v[136:139], v[32:47]
    v_mul_f32 v80, v48, v104
    v_mul_f32 v81, v49, v104
    v_mul_f32 v82, v50, v104
    ds_read_b64_tr_b16 v[72:73], v9 offset:6144
    ds_read_b64_tr_b16 v[74:75], v9 offset:6400
    s_waitcnt lgkmcnt(6)
    v_mfma_f32_32x32x16_bf16 v[32:47], v[76:79], v[140:143], v[32:47]
    v_mul_f32 v83, v51, v104
    v_mul_f32 v84, v52, v104
    v_mul_f32 v85, v53, v104
    ds_read_b64_tr_b16 v[76:77], v9 offset:7168
    ds_read_b64_tr_b16 v[78:79], v9 offset:7424
    s_waitcnt lgkmcnt(6)
    v_mfma_f32_32x32x16_bf16 v[32:47], v[64:67], v[144:147], v[32:47]
    s_add_u32 m0, s44, 1024
    s_add_u32 s48, s46, 57472
    buffer_load_dwordx4 v6, s[28:31], s48 offen lds
    v_mul_f32 v86, v54, v104
    v_mul_f32 v87, v55, v104
    v_exp_f32 v80, v80
    ds_read_b64_tr_b16 v[64:65], v9 offset:8192
    ds_read_b64_tr_b16 v[66:67], v9 offset:8448
    s_waitcnt lgkmcnt(6)
    v_mfma_f32_32x32x16_bf16 v[32:47], v[68:71], v[148:151], v[32:47]
    v_exp_f32 v81, v81
    v_exp_f32 v82, v82
    v_exp_f32 v83, v83
    ds_read_b64_tr_b16 v[68:69], v9 offset:9216
    ds_read_b64_tr_b16 v[70:71], v9 offset:9472
    s_waitcnt lgkmcnt(6)
    v_mfma_f32_32x32x16_bf16 v[32:47], v[72:75], v[152:155], v[32:47]
    v_exp_f32 v84, v84
    v_exp_f32 v85, v85
    v_exp_f32 v86, v86
    ds_read_b64_tr_b16 v[72:73], v9 offset:10240
    ds_read_b64_tr_b16 v[74:75], v9 offset:10496
    s_waitcnt lgkmcnt(6)
    v_mfma_f32_32x32x16_bf16 v[32:47], v[76:79], v[156:159], v[32:47]
    v_exp_f32 v87, v87
    v_mul_f32 v56, v48, v56
    v_mul_f32 v57, v49, v57
    ds_read_b64_tr_b16 v[76:77], v9 offset:11264
    ds_read_b64_tr_b16 v[78:79], v9 offset:11520
    s_waitcnt lgkmcnt(6)
    v_mfma_f32_32x32x16_bf16 v[32:47], v[64:67], v[160:163], v[32:47]
    s_add_u32 m0, s44, 2048
    s_add_u32 s47, s46, 114816
    buffer_load_dwordx4 v6, s[28:31], s47 offen lds
    v_mul_f32 v58, v50, v58
    v_mul_f32 v59, v51, v59
    v_mul_f32 v60, v52, v60
    ds_read_b64_tr_b16 v[64:65], v9 offset:12288
    ds_read_b64_tr_b16 v[66:67], v9 offset:12544
    s_waitcnt lgkmcnt(6)
    v_mfma_f32_32x32x16_bf16 v[32:47], v[68:71], v[164:167], v[32:47]
    v_mul_f32 v61, v53, v61
    v_mul_f32 v62, v54, v62
    v_mul_f32 v63, v55, v63
    ds_read_b64_tr_b16 v[68:69], v9 offset:13312
    ds_read_b64_tr_b16 v[70:71], v9 offset:13568
    s_waitcnt lgkmcnt(6)
    v_mfma_f32_32x32x16_bf16 v[32:47], v[72:75], v[168:171], v[32:47]
    v_fma_f32 v80, v80, v105, v105
    v_fma_f32 v81, v81, v105, v105
    v_fma_f32 v82, v82, v105, v105
    ds_read_b64_tr_b16 v[72:73], v9 offset:14336
    ds_read_b64_tr_b16 v[74:75], v9 offset:14592
    s_waitcnt lgkmcnt(6)
    v_mfma_f32_32x32x16_bf16 v[32:47], v[76:79], v[172:175], v[32:47]
    v_fma_f32 v83, v83, v105, v105
    v_fma_f32 v84, v84, v105, v105
    v_fma_f32 v85, v85, v105, v105
    ds_read_b64_tr_b16 v[76:77], v9 offset:15360
    ds_read_b64_tr_b16 v[78:79], v9 offset:15616
    s_waitcnt lgkmcnt(6)
    v_mfma_f32_32x32x16_bf16 v[32:47], v[64:67], v[176:179], v[32:47]
    s_add_u32 m0, s44, 3072
    s_add_u32 s48, s46, 172160
    buffer_load_dwordx4 v6, s[28:31], s48 offen lds
    v_fma_f32 v86, v86, v105, v105
    v_fma_f32 v87, v87, v105, v105
    v_rcp_f32 v80, v80
    s_waitcnt vmcnt(5)
    s_barrier
    v_add_u32 v9, 131072, v8
    ds_read_b64_tr_b16 v[64:65], v9 offset:0
    ds_read_b64_tr_b16 v[66:67], v9 offset:256
    s_waitcnt lgkmcnt(6)
    v_mfma_f32_32x32x16_bf16 v[32:47], v[68:71], v[180:183], v[32:47]
    v_rcp_f32 v81, v81
    v_rcp_f32 v82, v82
    v_rcp_f32 v83, v83
    ds_read_b64_tr_b16 v[68:69], v9 offset:1024
    ds_read_b64_tr_b16 v[70:71], v9 offset:1280
    s_waitcnt lgkmcnt(6)
    v_mfma_f32_32x32x16_bf16 v[32:47], v[72:75], v[184:187], v[32:47]
    v_rcp_f32 v84, v84
    v_rcp_f32 v85, v85
    v_rcp_f32 v86, v86
    ds_read_b64_tr_b16 v[72:73], v9 offset:2048
    ds_read_b64_tr_b16 v[74:75], v9 offset:2304
    s_waitcnt lgkmcnt(6)
    v_mfma_f32_32x32x16_bf16 v[32:47], v[76:79], v[188:191], v[32:47]
    v_rcp_f32 v87, v87
    v_mul_f32 v56, v56, v80
    v_mul_f32 v57, v57, v81
    ds_read_b64_tr_b16 v[76:77], v9 offset:3072
    ds_read_b64_tr_b16 v[78:79], v9 offset:3328
    s_waitcnt lgkmcnt(6)
    v_mfma_f32_32x32x16_bf16 v[32:47], v[64:67], v[192:195], v[32:47]
    s_add_u32 m0, s44, 32768
    s_add_u32 s47, s46, 917632
    buffer_load_dwordx4 v6, s[28:31], s47 offen lds
    v_mul_f32 v58, v58, v82
    v_mul_f32 v59, v59, v83
    v_mul_f32 v60, v60, v84
    ds_read_b64_tr_b16 v[64:65], v9 offset:4096
    ds_read_b64_tr_b16 v[66:67], v9 offset:4352
    s_waitcnt lgkmcnt(6)
    v_mfma_f32_32x32x16_bf16 v[32:47], v[68:71], v[196:199], v[32:47]
    v_mul_f32 v61, v61, v85
    v_mul_f32 v62, v62, v86
    v_mul_f32 v63, v63, v87
    ds_read_b64_tr_b16 v[68:69], v9 offset:5120
    ds_read_b64_tr_b16 v[70:71], v9 offset:5376
    s_waitcnt lgkmcnt(6)
    v_mfma_f32_32x32x16_bf16 v[32:47], v[72:75], v[200:203], v[32:47]
    v_cvt_pk_bf16_f32 v88, v56, v57
    v_cvt_pk_bf16_f32 v89, v58, v59
    v_cvt_pk_bf16_f32 v90, v60, v61
    ds_read_b64_tr_b16 v[72:73], v9 offset:6144
    ds_read_b64_tr_b16 v[74:75], v9 offset:6400
    s_waitcnt lgkmcnt(6)
    v_mfma_f32_32x32x16_bf16 v[32:47], v[76:79], v[204:207], v[32:47]
    v_cvt_pk_bf16_f32 v91, v62, v63
    ds_read_b64_tr_b16 v[76:77], v9 offset:7168
    ds_read_b64_tr_b16 v[78:79], v9 offset:7424
    s_waitcnt lgkmcnt(6)
    v_mfma_f32_32x32x16_bf16 v[32:47], v[64:67], v[208:211], v[32:47]
    s_add_u32 m0, s44, 33792
    s_add_u32 s48, s46, 974976
    buffer_load_dwordx4 v6, s[28:31], s48 offen lds
    ds_read_b64_tr_b16 v[64:65], v9 offset:8192
    ds_read_b64_tr_b16 v[66:67], v9 offset:8448
    s_waitcnt lgkmcnt(6)
    v_mfma_f32_32x32x16_bf16 v[32:47], v[68:71], v[212:215], v[32:47]
    ds_read_b64_tr_b16 v[68:69], v9 offset:9216
    ds_read_b64_tr_b16 v[70:71], v9 offset:9472
    s_waitcnt lgkmcnt(6)
    v_mfma_f32_32x32x16_bf16 v[32:47], v[72:75], v[216:219], v[32:47]
    ds_read_b64_tr_b16 v[72:73], v9 offset:10240
    ds_read_b64_tr_b16 v[74:75], v9 offset:10496
    s_waitcnt lgkmcnt(6)
    v_mfma_f32_32x32x16_bf16 v[32:47], v[76:79], v[220:223], v[32:47]
    ds_read_b64_tr_b16 v[76:77], v9 offset:11264
    ds_read_b64_tr_b16 v[78:79], v9 offset:11520
    s_waitcnt lgkmcnt(6)
    v_mfma_f32_32x32x16_bf16 v[32:47], v[64:67], v[224:227], v[32:47]
    s_add_u32 m0, s44, 34816
    s_add_u32 s47, s46, 1032320
    buffer_load_dwordx4 v6, s[28:31], s47 offen lds
    ds_read_b64_tr_b16 v[64:65], v9 offset:12288
    ds_read_b64_tr_b16 v[66:67], v9 offset:12544
    s_waitcnt lgkmcnt(6)
    v_mfma_f32_32x32x16_bf16 v[32:47], v[68:71], v[228:231], v[32:47]
    ds_read_b64_tr_b16 v[68:69], v9 offset:13312
    ds_read_b64_tr_b16 v[70:71], v9 offset:13568
    s_waitcnt lgkmcnt(6)
    v_mfma_f32_32x32x16_bf16 v[32:47], v[72:75], v[232:235], v[32:47]
    ds_read_b64_tr_b16 v[72:73], v9 offset:14336
    ds_read_b64_tr_b16 v[74:75], v9 offset:14592
    s_waitcnt lgkmcnt(6)
    v_mfma_f32_32x32x16_bf16 v[32:47], v[76:79], v[236:239], v[32:47]
    ds_read_b64_tr_b16 v[76:77], v9 offset:15360
    ds_read_b64_tr_b16 v[78:79], v9 offset:15616
    s_waitcnt lgkmcnt(6)
    v_mfma_f32_32x32x16_bf16 v[32:47], v[64:67], v[240:243], v[32:47]
    s_add_u32 m0, s44, 35840
    s_add_u32 s48, s46, 1089664
    buffer_load_dwordx4 v6, s[28:31], s48 offen lds
    s_waitcnt vmcnt(4)
    s_barrier
    v_add_u32 v9, 0, v8
    v_mov_b32 v28, 1
    buffer_store_dword v28, v31, s[36:39], s97 offen sc1
    v_bfe_u32 v26, v2, 4, 6
    v_bfe_u32 v27, v26, 1, 4
    v_and_b32 v28, 1, v26
    s_lshr_b32 s65, s93, 2
    s_lshl_b32 s65, s65, 1
    v_add_u32 v28, s65, v28
    v_lshrrev_b32 v29, 2, v27
    v_lshrrev_b32 v25, 3, v28
    v_lshl_add_u32 v29, v25, 2, v29
    v_and_b32 v25, 3, v27
    v_lshl_add_u32 v29, v25, 3, v29
    v_and_b32 v25, 7, v28
    v_lshl_add_u32 v29, v25, 5, v29
    v_lshlrev_b32 v29, 7, v29
    v_add_u32 v29, 0xb00000, v29
    s_cmp_eq_u32 s40, 0
    s_cselect_b32 s65, 0, 0x40000000
    v_add_u32 v29, s65, v29
    v_bfe_u32 v28, v2, 4, 1
    v_lshlrev_b32 v28, 7, v28
    s_cmp_eq_u32 s40, 0
    s_cselect_b32 s65, 0, 0x40000000
    v_add_u32 v28, s65, v28
    buffer_load_dword v27, v28, s[68:71], 0 offen sc1
    ds_read_b64_tr_b16 v[64:65], v9 offset:0
    ds_read_b64_tr_b16 v[66:67], v9 offset:256
    s_waitcnt lgkmcnt(6)
    v_mfma_f32_32x32x16_bf16 v[32:47], v[68:71], v[244:247], v[32:47]
    s_add_u32 s67, s51, 0
    buffer_store_dwordx4 v[88:91], v2, s[36:39], s67 offen sc1
    ds_read_b64_tr_b16 v[68:69], v9 offset:1024
    ds_read_b64_tr_b16 v[70:71], v9 offset:1280
    s_waitcnt lgkmcnt(6)
    v_mfma_f32_32x32x16_bf16 v[32:47], v[72:75], v[248:251], v[32:47]
    ds_read_b64_tr_b16 v[72:73], v9 offset:2048
    ds_read_b64_tr_b16 v[74:75], v9 offset:2304
    s_waitcnt lgkmcnt(6)
    v_mfma_f32_32x32x16_bf16 v[32:47], v[76:79], v[252:255], v[32:47]
    ds_read_b64_tr_b16 v[76:77], v9 offset:3072
    ds_read_b64_tr_b16 v[78:79], v9 offset:3328
    s_waitcnt lgkmcnt(6)
    v_mfma_f32_32x32x16_bf16 v[48:63], v[64:67], v[128:131], 0
    s_add_u32 m0, s44, 65536
    s_add_u32 s47, s46, 192
    buffer_load_dwordx4 v6, s[28:31], s47 offen lds
    ds_read_b64_tr_b16 v[64:65], v9 offset:4096
    ds_read_b64_tr_b16 v[66:67], v9 offset:4352
    s_waitcnt lgkmcnt(6)
    v_mfma_f32_32x32x16_bf16 v[48:63], v[68:71], v[132:135], v[48:63]
    ds_read_b64_tr_b16 v[68:69], v9 offset:5120
    ds_read_b64_tr_b16 v[70:71], v9 offset:5376
    s_waitcnt lgkmcnt(6)
    v_mfma_f32_32x32x16_bf16 v[48:63], v[72:75], v[136:139], v[48:63]
    v_mul_f32 v80, v32, v104
    v_mul_f32 v81, v33, v104
    v_mul_f32 v82, v34, v104
    ds_read_b64_tr_b16 v[72:73], v9 offset:6144
    ds_read_b64_tr_b16 v[74:75], v9 offset:6400
    s_waitcnt lgkmcnt(6)
    v_mfma_f32_32x32x16_bf16 v[48:63], v[76:79], v[140:143], v[48:63]
    v_mul_f32 v83, v35, v104
    v_mul_f32 v84, v36, v104
    v_mul_f32 v85, v37, v104
    ds_read_b64_tr_b16 v[76:77], v9 offset:7168
    ds_read_b64_tr_b16 v[78:79], v9 offset:7424
    s_waitcnt lgkmcnt(6)
    v_mfma_f32_32x32x16_bf16 v[48:63], v[64:67], v[144:147], v[48:63]
    s_add_u32 m0, s44, 66560
    s_add_u32 s48, s46, 57536
    buffer_load_dwordx4 v6, s[28:31], s48 offen lds
    v_mul_f32 v86, v38, v104
    v_mul_f32 v87, v39, v104
    v_exp_f32 v80, v80
    ds_read_b64_tr_b16 v[64:65], v9 offset:8192
    ds_read_b64_tr_b16 v[66:67], v9 offset:8448
    s_waitcnt lgkmcnt(6)
    v_mfma_f32_32x32x16_bf16 v[48:63], v[68:71], v[148:151], v[48:63]
    v_exp_f32 v81, v81
    v_exp_f32 v82, v82
    v_exp_f32 v83, v83
    ds_read_b64_tr_b16 v[68:69], v9 offset:9216
    ds_read_b64_tr_b16 v[70:71], v9 offset:9472
    s_waitcnt lgkmcnt(6)
    v_mfma_f32_32x32x16_bf16 v[48:63], v[72:75], v[152:155], v[48:63]
    v_exp_f32 v84, v84
    v_exp_f32 v85, v85
    v_exp_f32 v86, v86
    ds_read_b64_tr_b16 v[72:73], v9 offset:10240
    ds_read_b64_tr_b16 v[74:75], v9 offset:10496
    s_waitcnt lgkmcnt(6)
    v_mfma_f32_32x32x16_bf16 v[48:63], v[76:79], v[156:159], v[48:63]
    v_exp_f32 v87, v87
    v_mul_f32 v40, v32, v40
    v_mul_f32 v41, v33, v41
    ds_read_b64_tr_b16 v[76:77], v9 offset:11264
    ds_read_b64_tr_b16 v[78:79], v9 offset:11520
    s_waitcnt lgkmcnt(6)
    v_mfma_f32_32x32x16_bf16 v[48:63], v[64:67], v[160:163], v[48:63]
    s_add_u32 m0, s44, 67584
    s_add_u32 s47, s46, 114880
    buffer_load_dwordx4 v6, s[28:31], s47 offen lds
    v_mul_f32 v42, v34, v42
    v_mul_f32 v43, v35, v43
    v_mul_f32 v44, v36, v44
    ds_read_b64_tr_b16 v[64:65], v9 offset:12288
    ds_read_b64_tr_b16 v[66:67], v9 offset:12544
    s_waitcnt lgkmcnt(6)
    v_mfma_f32_32x32x16_bf16 v[48:63], v[68:71], v[164:167], v[48:63]
    v_mul_f32 v45, v37, v45
    v_mul_f32 v46, v38, v46
    v_mul_f32 v47, v39, v47
    ds_read_b64_tr_b16 v[68:69], v9 offset:13312
    ds_read_b64_tr_b16 v[70:71], v9 offset:13568
    s_waitcnt lgkmcnt(6)
    v_mfma_f32_32x32x16_bf16 v[48:63], v[72:75], v[168:171], v[48:63]
    v_fma_f32 v80, v80, v105, v105
    v_fma_f32 v81, v81, v105, v105
    v_fma_f32 v82, v82, v105, v105
    ds_read_b64_tr_b16 v[72:73], v9 offset:14336
    ds_read_b64_tr_b16 v[74:75], v9 offset:14592
    s_waitcnt lgkmcnt(6)
    v_mfma_f32_32x32x16_bf16 v[48:63], v[76:79], v[172:175], v[48:63]
    v_fma_f32 v83, v83, v105, v105
    v_fma_f32 v84, v84, v105, v105
    v_fma_f32 v85, v85, v105, v105
    ds_read_b64_tr_b16 v[76:77], v9 offset:15360
    ds_read_b64_tr_b16 v[78:79], v9 offset:15616
    s_waitcnt lgkmcnt(6)
    v_mfma_f32_32x32x16_bf16 v[48:63], v[64:67], v[176:179], v[48:63]
    s_add_u32 m0, s44, 68608
    s_add_u32 s48, s46, 172224
    buffer_load_dwordx4 v6, s[28:31], s48 offen lds
    v_fma_f32 v86, v86, v105, v105
    v_fma_f32 v87, v87, v105, v105
    v_rcp_f32 v80, v80
    s_waitcnt vmcnt(7)
    s_waitcnt vmcnt(5)
    s_cmp_lg_u32 s40, 0
    s_cbranch_scc1 L_ok2
    v_mov_b32 v28, 128
    v_cmp_gt_u32 vcc, v28, v27
    s_nop 4
    s_cbranch_vccz L_ok2
    s_mov_b32 s98, 0
L_spin2:
    v_bfe_u32 v28, v2, 4, 1
    v_lshlrev_b32 v28, 7, v28
    s_cmp_eq_u32 s40, 0
    s_cselect_b32 s65, 0, 0x40000000
    v_add_u32 v28, s65, v28
    buffer_load_dword v27, v28, s[68:71], 0 offen sc1
    s_waitcnt vmcnt(0)
    v_mov_b32 v28, 128
    v_cmp_gt_u32 vcc, v28, v27
    s_add_u32 s98, s98, 1
    s_cmp_gt_u32 s98, 200000
    s_cbranch_scc1 L_ok2
    s_nop 1
    s_cbranch_vccnz L_spin2
L_ok2:
    s_barrier
    v_add_u32 v9, 32768, v8
    buffer_load_dword v30, v29, s[36:39], 0 offen sc1
    ds_read_b64_tr_b16 v[64:65], v9 offset:0
    ds_read_b64_tr_b16 v[66:67], v9 offset:256
    s_waitcnt lgkmcnt(6)
    v_mfma_f32_32x32x16_bf16 v[48:63], v[68:71], v[180:183], v[48:63]
    v_rcp_f32 v81, v81
    v_rcp_f32 v82, v82
    v_rcp_f32 v83, v83
    ds_read_b64_tr_b16 v[68:69], v9 offset:1024
    ds_read_b64_tr_b16 v[70:71], v9 offset:1280
    s_waitcnt lgkmcnt(6)
    v_mfma_f32_32x32x16_bf16 v[48:63], v[72:75], v[184:187], v[48:63]
    v_rcp_f32 v84, v84
    v_rcp_f32 v85, v85
    v_rcp_f32 v86, v86
    ds_read_b64_tr_b16 v[72:73], v9 offset:2048
    ds_read_b64_tr_b16 v[74:75], v9 offset:2304
    s_waitcnt lgkmcnt(6)
    v_mfma_f32_32x32x16_bf16 v[48:63], v[76:79], v[188:191], v[48:63]
    v_rcp_f32 v87, v87
    v_mul_f32 v40, v40, v80
    v_mul_f32 v41, v41, v81
    ds_read_b64_tr_b16 v[76:77], v9 offset:3072
    ds_read_b64_tr_b16 v[78:79], v9 offset:3328
    s_waitcnt lgkmcnt(6)
    v_mfma_f32_32x32x16_bf16 v[48:63], v[64:67], v[192:195], v[48:63]
    s_add_u32 m0, s44, 98304
    s_add_u32 s47, s46, 917696
    buffer_load_dwordx4 v6, s[28:31], s47 offen lds
    v_mul_f32 v42, v42, v82
    v_mul_f32 v43, v43, v83
    v_mul_f32 v44, v44, v84
    ds_read_b64_tr_b16 v[64:65], v9 offset:4096
    ds_read_b64_tr_b16 v[66:67], v9 offset:4352
    s_waitcnt lgkmcnt(6)
    v_mfma_f32_32x32x16_bf16 v[48:63], v[68:71], v[196:199], v[48:63]
    v_mul_f32 v45, v45, v85
    v_mul_f32 v46, v46, v86
    v_mul_f32 v47, v47, v87
    ds_read_b64_tr_b16 v[68:69], v9 offset:5120
    ds_read_b64_tr_b16 v[70:71], v9 offset:5376
    s_waitcnt lgkmcnt(6)
    v_mfma_f32_32x32x16_bf16 v[48:63], v[72:75], v[200:203], v[48:63]
    v_cvt_pk_bf16_f32 v88, v40, v41
    v_cvt_pk_bf16_f32 v89, v42, v43
    v_cvt_pk_bf16_f32 v90, v44, v45
    ds_read_b64_tr_b16 v[72:73], v9 offset:6144
    ds_read_b64_tr_b16 v[74:75], v9 offset:6400
    s_waitcnt lgkmcnt(6)
    v_mfma_f32_32x32x16_bf16 v[48:63], v[76:79], v[204:207], v[48:63]
    v_cvt_pk_bf16_f32 v91, v46, v47
    ds_read_b64_tr_b16 v[76:77], v9 offset:7168
    ds_read_b64_tr_b16 v[78:79], v9 offset:7424
    s_waitcnt lgkmcnt(6)
    v_mfma_f32_32x32x16_bf16 v[48:63], v[64:67], v[208:211], v[48:63]
    s_add_u32 m0, s44, 99328
    s_add_u32 s48, s46, 975040
    buffer_load_dwordx4 v6, s[28:31], s48 offen lds
    ds_read_b64_tr_b16 v[64:65], v9 offset:8192
    ds_read_b64_tr_b16 v[66:67], v9 offset:8448
    s_waitcnt lgkmcnt(6)
    v_mfma_f32_32x32x16_bf16 v[48:63], v[68:71], v[212:215], v[48:63]
    ds_read_b64_tr_b16 v[68:69], v9 offset:9216
    ds_read_b64_tr_b16 v[70:71], v9 offset:9472
    s_waitcnt lgkmcnt(6)
    v_mfma_f32_32x32x16_bf16 v[48:63], v[72:75], v[216:219], v[48:63]
    ds_read_b64_tr_b16 v[72:73], v9 offset:10240
    ds_read_b64_tr_b16 v[74:75], v9 offset:10496
    s_waitcnt lgkmcnt(6)
    v_mfma_f32_32x32x16_bf16 v[48:63], v[76:79], v[220:223], v[48:63]
    ds_read_b64_tr_b16 v[76:77], v9 offset:11264
    ds_read_b64_tr_b16 v[78:79], v9 offset:11520
    s_waitcnt lgkmcnt(6)
    v_mfma_f32_32x32x16_bf16 v[48:63], v[64:67], v[224:227], v[48:63]
    s_add_u32 m0, s44, 100352
    s_add_u32 s47, s46, 1032384
    buffer_load_dwordx4 v6, s[28:31], s47 offen lds
    ds_read_b64_tr_b16 v[64:65], v9 offset:12288
    ds_read_b64_tr_b16 v[66:67], v9 offset:12544
    s_waitcnt lgkmcnt(6)
    v_mfma_f32_32x32x16_bf16 v[48:63], v[68:71], v[228:231], v[48:63]
    ds_read_b64_tr_b16 v[68:69], v9 offset:13312
    ds_read_b64_tr_b16 v[70:71], v9 offset:13568
    s_waitcnt lgkmcnt(6)
    v_mfma_f32_32x32x16_bf16 v[48:63], v[72:75], v[232:235], v[48:63]
    ds_read_b64_tr_b16 v[72:73], v9 offset:14336
    ds_read_b64_tr_b16 v[74:75], v9 offset:14592
    s_waitcnt lgkmcnt(6)
    v_mfma_f32_32x32x16_bf16 v[48:63], v[76:79], v[236:239], v[48:63]
    ds_read_b64_tr_b16 v[76:77], v9 offset:15360
    ds_read_b64_tr_b16 v[78:79], v9 offset:15616
    s_waitcnt lgkmcnt(6)
    v_mfma_f32_32x32x16_bf16 v[48:63], v[64:67], v[240:243], v[48:63]
    s_add_u32 m0, s44, 101376
    s_add_u32 s48, s46, 1089728
    buffer_load_dwordx4 v6, s[28:31], s48 offen lds
    s_waitcnt vmcnt(5)
    s_waitcnt vmcnt(4)
    s_cmp_lg_u32 s40, 0
    s_cbranch_scc1 L_ok3
    v_and_b32 v30, 1, v30
    v_cmp_ne_u32 vcc, 1, v30
    s_nop 4
    s_cbranch_vccz L_ok3
    s_mov_b32 s98, 0
L_spin3:
    buffer_load_dword v30, v29, s[36:39], 0 offen sc1
    s_waitcnt vmcnt(0)
    v_and_b32 v30, 1, v30
    v_cmp_ne_u32 vcc, 1, v30
    s_add_u32 s98, s98, 1
    s_cmp_gt_u32 s98, 200000
    s_cbranch_scc1 L_ok3
    s_nop 1
    s_cbranch_vccnz L_spin3
L_ok3:
    s_barrier
    v_add_u32 v9, 65536, v8
    s_lshl_b32 s65, s94, 3
    s_add_u32 s65, s65, s40
    s_lshl_b32 s66, s93, 6
    s_add_u32 s66, s66, s65
    s_lshl_b32 s66, s66, 10
    buffer_load_dwordx4 v[112:115], v2, s[36:39], s66 offen sc1
    ds_read_b64_tr_b16 v[64:65], v9 offset:0
    ds_read_b64_tr_b16 v[66:67], v9 offset:256
    s_waitcnt lgkmcnt(6)
    v_mfma_f32_32x32x16_bf16 v[48:63], v[68:71], v[244:247], v[48:63]
    s_add_u32 s67, s51, 2048
    buffer_store_dwordx4 v[88:91], v2, s[36:39], s67 offen sc1
    ds_read_b64_tr_b16 v[68:69], v9 offset:1024
    ds_read_b64_tr_b16 v[70:71], v9 offset:1280
    s_waitcnt lgkmcnt(6)
    v_mfma_f32_32x32x16_bf16 v[48:63], v[72:75], v[248:251], v[48:63]
    v_lshlrev_b32 v26, 3, v0
    v_add_u32 v26, 131072, v26
    v_mov_b32 v24, 0x3f803f80
    ds_read_b64_tr_b16 v[72:73], v9 offset:2048
    ds_read_b64_tr_b16 v[74:75], v9 offset:2304
    s_waitcnt lgkmcnt(6)
    v_mfma_f32_32x32x16_bf16 v[48:63], v[76:79], v[252:255], v[48:63]
    v_mov_b32 v25, 0x3f803f80
    ds_write_b64 v26, v[24:25]
    v_mov_b32 v14, 0
    v_mov_b32 v15, 0
    ds_write_b64 v26, v[14:15] offset:4096
    v_bfe_u32 v24, v2, 4, 4
    v_lshlrev_b32 v24, 4, v24
    v_lshrrev_b32 v25, 9, v2
    v_lshl_add_u32 v24, v25, 8, v24
    v_add_u32 v24, 16384, v24
    v_bfe_u32 v25, v2, 4, 5
    v_subrev_u32 v26, 20, v25
    v_cmp_gt_u32 vcc, 8, v26
    v_mov_b32 v27, 135168
    v_mov_b32 v14, 135232
    v_cndmask_b32 v27, v27, v14, vcc
    v_cmp_eq_u32 vcc, 16, v25
    v_mov_b32 v14, 131264
    s_nop 0
    v_cndmask_b32 v27, v27, v14, vcc
    v_cmp_gt_u32 vcc, 16, v25
    v_mov_b32 v14, 4096
    v_mov_b32 v15, 20480
    v_cndmask_b32 v3, v27, v24, vcc
    v_cndmask_b32 v4, 0, v14, vcc
    v_cndmask_b32 v5, 0, v15, vcc
    v_add_u32 v10, 65536, v2
    ds_read_b64_tr_b16 v[76:77], v9 offset:3072
    ds_read_b64_tr_b16 v[78:79], v9 offset:3328
    s_waitcnt lgkmcnt(8)
    v_mfma_f32_32x32x16_bf16 v[32:47], v[64:67], v[128:131], 0
    s_add_u32 m0, s96, 0
    s_add_u32 s47, s95, 0x200000
    buffer_load_dwordx4 v2, s[36:39], s47 offen sc1 lds
    buffer_load_dwordx4 v2, s[36:39], s47 offen offset:1024 sc1 lds
    ds_read_b64_tr_b16 v[64:65], v9 offset:4096
    ds_read_b64_tr_b16 v[66:67], v9 offset:4352
    s_waitcnt lgkmcnt(8)
    v_mfma_f32_32x32x16_bf16 v[32:47], v[68:71], v[132:135], v[32:47]
    v_bfe_u32 v26, v2, 6, 4
    v_lshlrev_b32 v26, 10, v26
    v_bfe_u32 v27, v2, 4, 2
    v_lshl_add_u32 v26, v27, 4, v26
    s_lshr_b32 s65, s2, 4
    s_mul_i32 s65, s65, 9
    s_add_u32 s65, s65, s40
    s_and_b32 s66, s2, 15
    s_mul_i32 s57, s66, 144
    s_add_u32 s57, s57, s65
    s_lshl_b32 s57, s57, 10
    s_add_u32 s57, s57, 0x800000
    s_sub_u32 s67, s65, 112
    s_cmp_ge_u32 s65, 112
    s_cselect_b32 s65, s67, s65
    s_cselect_b32 s32, s8, s16
    s_cselect_b32 s33, s9, s17
    s_mov_b32 s34, 0x1c0000
    s_cselect_b32 s34, 0x80000, s34
    s_mov_b32 s35, 0x20000
    s_lshl_b32 s55, s65, 14
    s_lshl_b32 s66, s66, 6
    s_add_u32 s55, s55, s66
    s_lshl_b32 s66, s40, 11
    s_add_u32 m0, s66, 139264
    s_nop 0
    buffer_load_dwordx4 v26, s[32:35], s55 offen lds
    s_lshr_b32 s65, s2, 4
    s_mul_i32 s65, s65, 9
    s_add_u32 s65, s65, 8
    s_and_b32 s66, s2, 15
    s_mul_i32 s64, s66, 144
    s_add_u32 s64, s64, s65
    s_lshl_b32 s64, s64, 10
    s_add_u32 s64, s64, 0x800000
    s_sub_u32 s67, s65, 112
    s_cmp_ge_u32 s65, 112
    s_cselect_b32 s65, s67, s65
    s_cselect_b32 s60, s8, s16
    s_cselect_b32 s61, s9, s17
    s_mov_b32 s62, 0x1c0000
    s_cselect_b32 s62, 0x80000, s62
    s_mov_b32 s63, 0x20000
    s_lshl_b32 s58, s65, 14
    s_lshl_b32 s66, s66, 6
    s_add_u32 s58, s58, s66
    s_cmp_eq_u32 s40, 0
    s_cselect_b32 s64, s64, 0x1800000
    s_lshl_b32 s66, s40, 11
    s_add_u32 m0, s66, 140288
    s_nop 0
    buffer_load_dwordx4 v26, s[60:63], s58 offen lds
    ds_read_b64_tr_b16 v[68:69], v9 offset:5120
    ds_read_b64_tr_b16 v[70:71], v9 offset:5376
    s_waitcnt lgkmcnt(8)
    v_mfma_f32_32x32x16_bf16 v[32:47], v[72:75], v[136:139], v[32:47]
    v_mul_f32 v80, v48, v104
    v_mul_f32 v81, v49, v104
    v_mul_f32 v82, v50, v104
    ds_read_b64_tr_b16 v[72:73], v9 offset:6144
    ds_read_b64_tr_b16 v[74:75], v9 offset:6400
    s_waitcnt lgkmcnt(6)
    v_mfma_f32_32x32x16_bf16 v[32:47], v[76:79], v[140:143], v[32:47]
    v_mul_f32 v83, v51, v104
    v_mul_f32 v84, v52, v104
    v_mul_f32 v85, v53, v104
    ds_read_b64_tr_b16 v[76:77], v9 offset:7168
    ds_read_b64_tr_b16 v[78:79], v9 offset:7424
    s_waitcnt lgkmcnt(6)
    v_mfma_f32_32x32x16_bf16 v[32:47], v[64:67], v[144:147], v[32:47]
    s_and_b32 s65, s40, 1
    s_lshl_b32 s65, s65, 2
    s_add_u32 m0, s96, 16384
    s_add_u32 s47, s95, 0x400000
    buffer_load_dwordx4 v2, s[36:39], s47 offen sc1 lds
    buffer_load_dwordx4 v2, s[36:39], s47 offen offset:1024 sc1 lds
    v_mul_f32 v86, v54, v104
    v_mul_f32 v87, v55, v104
    v_exp_f32 v80, v80
    ds_read_b64_tr_b16 v[64:65], v9 offset:8192
    ds_read_b64_tr_b16 v[66:67], v9 offset:8448
    s_waitcnt lgkmcnt(6)
    v_mfma_f32_32x32x16_bf16 v[32:47], v[68:71], v[148:151], v[32:47]
    s_lshr_b32 s66, s40, 1
    s_add_u32 s65, s65, s66
    v_exp_f32 v81, v81
    v_exp_f32 v82, v82
    v_exp_f32 v83, v83
    ds_read_b64_tr_b16 v[68:69], v9 offset:9216
    ds_read_b64_tr_b16 v[70:71], v9 offset:9472
    s_waitcnt lgkmcnt(6)
    v_mfma_f32_32x32x16_bf16 v[32:47], v[72:75], v[152:155], v[32:47]
    s_lshl_b32 s65, s65, 13
    v_bfe_u32 v21, v2, 4, 5
    v_exp_f32 v84, v84
    v_exp_f32 v85, v85
    v_exp_f32 v86, v86
    ds_read_b64_tr_b16 v[72:73], v9 offset:10240
    ds_read_b64_tr_b16 v[74:75], v9 offset:10496
    s_waitcnt lgkmcnt(6)
    v_mfma_f32_32x32x16_bf16 v[32:47], v[76:79], v[156:159], v[32:47]
    v_lshrrev_b32 v20, 9, v2
    v_add_u32 v12, 0, v20
    v_exp_f32 v87, v87
    v_mul_f32 v56, v48, v56
    v_mul_f32 v57, v49, v57
    ds_read_b64_tr_b16 v[76:77], v9 offset:11264
    ds_read_b64_tr_b16 v[78:79], v9 offset:11520
    s_waitcnt lgkmcnt(6)
    v_mfma_f32_32x32x16_bf16 v[32:47], v[64:67], v[160:163], v[32:47]
    v_xor_b32 v12, v12, v21
    v_and_b32 v12, 7, v12
    v_mul_f32 v58, v50, v58
    v_mul_f32 v59, v51, v59
    v_mul_f32 v60, v52, v60
    ds_read_b64_tr_b16 v[64:65], v9 offset:12288
    ds_read_b64_tr_b16 v[66:67], v9 offset:12544
    s_waitcnt lgkmcnt(6)
    v_mfma_f32_32x32x16_bf16 v[32:47], v[68:71], v[164:167], v[32:47]
    v_lshlrev_b32 v12, 4, v12
    v_lshl_add_u32 v12, v21, 8, v12
    v_mul_f32 v61, v53, v61
    v_mul_f32 v62, v54, v62
    v_mul_f32 v63, v55, v63
    ds_read_b64_tr_b16 v[68:69], v9 offset:13312
    ds_read_b64_tr_b16 v[70:71], v9 offset:13568
    s_waitcnt lgkmcnt(6)
    v_mfma_f32_32x32x16_bf16 v[32:47], v[72:75], v[168:171], v[32:47]
    v_add_u32 v12, s65, v12
    v_add_u32 v13, 2, v20
    v_fma_f32 v80, v80, v105, v105
    v_fma_f32 v81, v81, v105, v105
    v_fma_f32 v82, v82, v105, v105
    ds_read_b64_tr_b16 v[72:73], v9 offset:14336
    ds_read_b64_tr_b16 v[74:75], v9 offset:14592
    s_waitcnt lgkmcnt(6)
    v_mfma_f32_32x32x16_bf16 v[32:47], v[76:79], v[172:175], v[32:47]
    v_xor_b32 v13, v13, v21
    v_and_b32 v13, 7, v13
    v_fma_f32 v83, v83, v105, v105
    v_fma_f32 v84, v84, v105, v105
    v_fma_f32 v85, v85, v105, v105
    ds_read_b64_tr_b16 v[76:77], v9 offset:15360
    ds_read_b64_tr_b16 v[78:79], v9 offset:15616
    s_waitcnt lgkmcnt(6)
    v_mfma_f32_32x32x16_bf16 v[32:47], v[64:67], v[176:179], v[32:47]
    v_lshlrev_b32 v13, 4, v13
    v_lshl_add_u32 v13, v21, 8, v13
    v_fma_f32 v86, v86, v105, v105
    v_fma_f32 v87, v87, v105, v105
    v_rcp_f32 v80, v80
    s_waitcnt vmcnt(8)
    s_barrier
    v_add_u32 v9, 98304, v8
    ds_read_b64_tr_b16 v[64:65], v9 offset:0
    ds_read_b64_tr_b16 v[66:67], v9 offset:256
    s_waitcnt lgkmcnt(6)
    v_mfma_f32_32x32x16_bf16 v[32:47], v[68:71], v[180:183], v[32:47]
    v_add_u32 v13, s65, v13
    v_add_u32 v14, 4, v20
    v_rcp_f32 v81, v81
    v_rcp_f32 v82, v82
    v_rcp_f32 v83, v83
    ds_read_b64_tr_b16 v[68:69], v9 offset:1024
    ds_read_b64_tr_b16 v[70:71], v9 offset:1280
    s_waitcnt lgkmcnt(6)
    v_mfma_f32_32x32x16_bf16 v[32:47], v[72:75], v[184:187], v[32:47]
    v_xor_b32 v14, v14, v21
    v_and_b32 v14, 7, v14
    v_rcp_f32 v84, v84
    v_rcp_f32 v85, v85
    v_rcp_f32 v86, v86
    ds_read_b64_tr_b16 v[72:73], v9 offset:2048
    ds_read_b64_tr_b16 v[74:75], v9 offset:2304
    s_waitcnt lgkmcnt(6)
    v_mfma_f32_32x32x16_bf16 v[32:47], v[76:79], v[188:191], v[32:47]
    v_lshlrev_b32 v14, 4, v14
    v_lshl_add_u32 v14, v21, 8, v14
    v_rcp_f32 v87, v87
    v_mul_f32 v56, v56, v80
    v_mul_f32 v57, v57, v81
    ds_read_b64_tr_b16 v[76:77], v9 offset:3072
    ds_read_b64_tr_b16 v[78:79], v9 offset:3328
    s_waitcnt lgkmcnt(6)
    v_mfma_f32_32x32x16_bf16 v[32:47], v[64:67], v[192:195], v[32:47]
    v_add_u32 v14, s65, v14
    v_add_u32 v15, 6, v20
    v_mul_f32 v58, v58, v82
    v_mul_f32 v59, v59, v83
    v_mul_f32 v60, v60, v84
    ds_read_b64_tr_b16 v[64:65], v9 offset:4096
    ds_read_b64_tr_b16 v[66:67], v9 offset:4352
    s_waitcnt lgkmcnt(6)
    v_mfma_f32_32x32x16_bf16 v[32:47], v[68:71], v[196:199], v[32:47]
    v_xor_b32 v15, v15, v21
    v_and_b32 v15, 7, v15
    v_mul_f32 v61, v61, v85
    v_mul_f32 v62, v62, v86
    v_mul_f32 v63, v63, v87
    ds_read_b64_tr_b16 v[68:69], v9 offset:5120
    ds_read_b64_tr_b16 v[70:71], v9 offset:5376
    s_waitcnt lgkmcnt(6)
    v_mfma_f32_32x32x16_bf16 v[32:47], v[72:75], v[200:203], v[32:47]
    v_lshlrev_b32 v15, 4, v15
    v_lshl_add_u32 v15, v21, 8, v15
    v_cvt_pk_bf16_f32 v88, v56, v57
    v_cvt_pk_bf16_f32 v89, v58, v59
    v_cvt_pk_bf16_f32 v90, v60, v61
    ds_read_b64_tr_b16 v[72:73], v9 offset:6144
    ds_read_b64_tr_b16 v[74:75], v9 offset:6400
    s_waitcnt lgkmcnt(6)
    v_mfma_f32_32x32x16_bf16 v[32:47], v[76:79], v[204:207], v[32:47]
    v_add_u32 v15, s65, v15
    s_lshr_b32 s65, s40, 2
    v_cvt_pk_bf16_f32 v91, v62, v63
    ds_read_b64_tr_b16 v[76:77], v9 offset:7168
    ds_read_b64_tr_b16 v[78:79], v9 offset:7424
    s_waitcnt lgkmcnt(6)
    v_mfma_f32_32x32x16_bf16 v[32:47], v[64:67], v[208:211], v[32:47]
    s_lshl_b32 s65, s65, 15
    s_and_b32 s66, s40, 3
    ds_read_b64_tr_b16 v[64:65], v9 offset:8192
    ds_read_b64_tr_b16 v[66:67], v9 offset:8448
    s_waitcnt lgkmcnt(6)
    v_mfma_f32_32x32x16_bf16 v[32:47], v[68:71], v[212:215], v[32:47]
    s_lshl_b32 s66, s66, 11
    s_add_u32 s65, s65, s66
    ds_read_b64_tr_b16 v[68:69], v9 offset:9216
    ds_read_b64_tr_b16 v[70:71], v9 offset:9472
    s_waitcnt lgkmcnt(6)
    v_mfma_f32_32x32x16_bf16 v[32:47], v[72:75], v[216:219], v[32:47]
    v_lshrrev_b32 v20, 7, v2
    v_bfe_u32 v21, v2, 4, 3
    ds_read_b64_tr_b16 v[72:73], v9 offset:10240
    ds_read_b64_tr_b16 v[74:75], v9 offset:10496
    s_waitcnt lgkmcnt(6)
    v_mfma_f32_32x32x16_bf16 v[32:47], v[76:79], v[220:223], v[32:47]
    v_lshlrev_b32 v21, 1, v21
    v_xor_b32 v21, v21, v20
    ds_read_b64_tr_b16 v[76:77], v9 offset:11264
    ds_read_b64_tr_b16 v[78:79], v9 offset:11520
    s_waitcnt lgkmcnt(6)
    v_mfma_f32_32x32x16_bf16 v[32:47], v[64:67], v[224:227], v[32:47]
    v_lshlrev_b32 v21, 4, v21
    v_lshl_add_u32 v20, v20, 8, v21
    ds_read_b64_tr_b16 v[64:65], v9 offset:12288
    ds_read_b64_tr_b16 v[66:67], v9 offset:12544
    s_waitcnt lgkmcnt(6)
    v_mfma_f32_32x32x16_bf16 v[32:47], v[68:71], v[228:231], v[32:47]
    v_add_u32 v20, s65, v20
    v_xor_b32 v21, 16, v20
    ds_read_b64_tr_b16 v[68:69], v9 offset:13312
    ds_read_b64_tr_b16 v[70:71], v9 offset:13568
    s_waitcnt lgkmcnt(6)
    v_mfma_f32_32x32x16_bf16 v[32:47], v[72:75], v[232:235], v[32:47]
    v_lshrrev_b32 v24, 7, v2
    v_bfe_u32 v25, v2, 4, 3
    ds_read_b64_tr_b16 v[72:73], v9 offset:14336
    ds_read_b64_tr_b16 v[74:75], v9 offset:14592
    s_waitcnt lgkmcnt(6)
    v_mfma_f32_32x32x16_bf16 v[32:47], v[76:79], v[236:239], v[32:47]
    v_lshlrev_b32 v24, 10, v24
    v_lshl_add_u32 v11, v25, 4, v24
    ds_read_b64_tr_b16 v[76:77], v9 offset:15360
    ds_read_b64_tr_b16 v[78:79], v9 offset:15616
    s_waitcnt lgkmcnt(6)
    v_mfma_f32_32x32x16_bf16 v[32:47], v[64:67], v[240:243], v[32:47]
    s_waitcnt vmcnt(2)
    v_bfe_u32 v26, v2, 6, 2
    v_lshrrev_b32 v27, 9, v2
    v_lshl_add_u32 v26, v27, 2, v26
    v_lshlrev_b32 v26, 6, v26
    v_bfe_u32 v27, v2, 4, 2
    v_lshl_add_u32 v26, v27, 3, v26
    v_bfe_u32 v27, v2, 8, 1
    v_lshl_add_u32 v26, v27, 5, v26
    s_lshl_b32 s66, s40, 11
    s_add_u32 s66, s66, 139264
    v_add_u32 v26, s66, v26
    ds_read_b64_tr_b16 v[176:177], v26 offset:0
    ds_read_b64_tr_b16 v[178:179], v26 offset:512
    ds_read_b64_tr_b16 v[180:181], v26 offset:1024
    ds_read_b64_tr_b16 v[182:183], v26 offset:1536
    s_waitcnt lgkmcnt(8)
    v_mfma_f32_32x32x16_bf16 v[32:47], v[68:71], v[244:247], v[32:47]
    s_add_u32 s67, s51, 4096
    buffer_store_dwordx4 v[88:91], v2, s[36:39], s67 offen sc1
    s_waitcnt lgkmcnt(6)
    v_mfma_f32_32x32x16_bf16 v[32:47], v[72:75], v[248:251], v[32:47]
    s_waitcnt lgkmcnt(4)
    v_mfma_f32_32x32x16_bf16 v[32:47], v[76:79], v[252:255], v[32:47]
    s_waitcnt lgkmcnt(0)
    buffer_store_dwordx4 v[176:179], v2, s[36:39], s57 offen sc1
    buffer_store_dwordx4 v[180:183], v2, s[36:39], s64 offen sc1
    s_waitcnt vmcnt(3)
    s_barrier
    ds_read_b128 v[116:119], v2
    ds_read_b128 v[120:123], v3
    ds_read_b128 v[124:127], v3 offset:512
    v_mov_b32 v160, 0
    v_mov_b32 v161, 0
    v_mov_b32 v162, 0
    v_mov_b32 v163, 0
    v_mov_b32 v164, 0
    v_mov_b32 v165, 0
    v_mov_b32 v166, 0
    v_mov_b32 v167, 0
    v_mov_b32 v168, 0
    v_mov_b32 v169, 0
    v_mov_b32 v170, 0
    v_mov_b32 v171, 0
    v_mov_b32 v172, 0
    v_mov_b32 v173, 0
    v_mov_b32 v174, 0
    v_mov_b32 v175, 0
    v_mov_b32 v7, 0xdddddddd
    s_waitcnt lgkmcnt(2)
    v_mfma_f32_32x32x16_bf16 v[128:143], v[116:119], v[112:115], 0
    ds_read_b128 v[116:119], v2 offset:1024
    s_add_u32 m0, s96, 32768
    s_add_u32 s47, s95, 0x204000
    buffer_load_dwordx4 v2, s[36:39], s47 offen sc1 lds
    buffer_load_dwordx4 v2, s[36:39], s47 offen offset:1024 sc1 lds
    s_add_u32 m0, s96, 49152
    s_add_u32 s47, s95, 0x404000
    buffer_load_dwordx4 v2, s[36:39], s47 offen sc1 lds
    buffer_load_dwordx4 v2, s[36:39], s47 offen offset:1024 sc1 lds
    v_mul_f32 v80, v32, v104
    v_mul_f32 v81, v33, v104
    v_mul_f32 v82, v34, v104
    v_mul_f32 v83, v35, v104
    v_mul_f32 v84, v36, v104
    v_mul_f32 v85, v37, v104
    v_mul_f32 v86, v38, v104
    v_mul_f32 v87, v39, v104
    v_exp_f32 v80, v80
    v_exp_f32 v81, v81
    v_exp_f32 v82, v82
    v_exp_f32 v83, v83
    v_exp_f32 v84, v84
    v_exp_f32 v85, v85
    v_exp_f32 v86, v86
    v_exp_f32 v87, v87
    v_mul_f32 v40, v32, v40
    v_mul_f32 v41, v33, v41
    v_mul_f32 v42, v34, v42
    v_mul_f32 v43, v35, v43
    v_mul_f32 v44, v36, v44
    v_mul_f32 v45, v37, v45
    v_mul_f32 v46, v38, v46
    v_mul_f32 v47, v39, v47
    v_fma_f32 v80, v80, v105, v105
    v_fma_f32 v81, v81, v105, v105
    v_fma_f32 v82, v82, v105, v105
    v_fma_f32 v83, v83, v105, v105
    v_fma_f32 v84, v84, v105, v105
    v_fma_f32 v85, v85, v105, v105
    v_fma_f32 v86, v86, v105, v105
    v_fma_f32 v87, v87, v105, v105
    v_rcp_f32 v80, v80
    v_rcp_f32 v81, v81
    v_rcp_f32 v82, v82
    v_rcp_f32 v83, v83
    v_rcp_f32 v84, v84
    v_rcp_f32 v85, v85
    v_rcp_f32 v86, v86
    v_rcp_f32 v87, v87
    v_mul_f32 v40, v40, v80
    v_mul_f32 v41, v41, v81
    v_mul_f32 v42, v42, v82
    v_mul_f32 v43, v43, v83
    v_mul_f32 v44, v44, v84
    v_mul_f32 v45, v45, v85
    v_mul_f32 v46, v46, v86
    v_mul_f32 v47, v47, v87
    v_cvt_pk_bf16_f32 v88, v40, v41
    v_cvt_pk_bf16_f32 v89, v42, v43
    v_cvt_pk_bf16_f32 v90, v44, v45
    v_cvt_pk_bf16_f32 v91, v46, v47
    s_add_u32 s67, s51, 6144
    buffer_store_dwordx4 v[88:91], v2, s[36:39], s67 offen sc1
    s_nop 0
L_attn:
    v_exp_f32 v128, v128
    v_exp_f32 v129, v129
    v_exp_f32 v130, v130
    v_exp_f32 v131, v131
    v_exp_f32 v132, v132
    s_waitcnt lgkmcnt(0)
    v_mfma_f32_32x32x16_bf16 v[144:159], v[116:119], v[112:115], 0
    v_exp_f32 v133, v133
    v_exp_f32 v134, v134
    v_exp_f32 v135, v135
    v_exp_f32 v136, v136
    v_exp_f32 v137, v137
    v_smfmac_f32_32x32x32_bf16 v[160:175], v[120:123], v[128:135], v7
    ds_read_b128 v[116:119], v2 offset:2048
    ds_read_b128 v[120:123], v3 offset:1024
    ds_read_b128 v[96:99], v3 offset:1536
    v_exp_f32 v138, v138
    v_exp_f32 v139, v139
    v_exp_f32 v140, v140
    v_exp_f32 v141, v141
    v_exp_f32 v142, v142
    v_exp_f32 v143, v143
    s_and_b32 s65, s40, 1
    s_lshr_b32 s66, s40, 1
    s_mul_i32 s67, s66, 28
    s_lshl_b32 s47, s93, 1
    s_add_u32 s47, s47, s65
    s_mul_i32 s45, s47, 112
    s_add_u32 s45, s45, s67
    s_lshl_b32 s45, s45, 10
    s_add_u32 s45, s45, 0x1000000
    s_mul_i32 s48, s94, 288
    s_add_u32 s46, s48, s67
    s_lshl_b32 s46, s46, 10
    s_add_u32 s46, s46, 0x800000
    s_add_u32 s44, s46, 147456
    s_lshl_b32 s66, s66, 3
    s_lshl_b32 s50, s47, 5
    s_add_u32 s50, s50, s66
    s_lshl_b32 s50, s50, 10
    s_add_u32 s50, s50, 0x600000
    s_add_u32 s51, s48, s66
    s_lshl_b32 s51, s51, 10
    s_add_u32 s51, s51, 0x81c000
    s_add_u32 s55, s51, 147456
    s_lshl_b32 s49, s93, 6
    s_lshl_b32 s65, s40, 3
    s_add_u32 s49, s49, s65
    s_lshl_b32 s49, s49, 10
    s_lshl_b32 s65, s94, 7
    s_add_u32 s49, s49, s65
    s_add_u32 m0, s96, 65536
    s_add_u32 s47, s95, 0x208000
    buffer_load_dwordx4 v2, s[36:39], s47 offen sc1 lds
    buffer_load_dwordx4 v2, s[36:39], s47 offen offset:1024 sc1 lds
    v_exp_f32 v144, v144
    v_exp_f32 v145, v145
    v_smfmac_f32_32x32x32_bf16 v[160:175], v[124:127], v[136:143], v7
    v_exp_f32 v146, v146
    v_exp_f32 v147, v147
    v_exp_f32 v148, v148
    s_waitcnt lgkmcnt(0)
    v_mfma_f32_32x32x16_bf16 v[128:143], v[116:119], v[112:115], 0
    v_exp_f32 v149, v149
    v_exp_f32 v150, v150
    v_exp_f32 v151, v151
    v_exp_f32 v152, v152
    v_exp_f32 v153, v153
    v_smfmac_f32_32x32x32_bf16 v[160:175], v[120:123], v[144:151], v7
    ds_read_b128 v[116:119], v2 offset:3072
    ds_read_b128 v[120:123], v3 offset:2048
    ds_read_b128 v[124:127], v3 offset:2560
    v_exp_f32 v154, v154
    v_exp_f32 v155, v155
    v_exp_f32 v156, v156
    v_exp_f32 v157, v157
    v_exp_f32 v158, v158
    v_exp_f32 v159, v159
    s_add_u32 m0, s96, 81920
    s_add_u32 s47, s95, 0x408000
    buffer_load_dwordx4 v2, s[36:39], s47 offen sc1 lds
    buffer_load_dwordx4 v2, s[36:39], s47 offen offset:1024 sc1 lds
    v_exp_f32 v128, v128
    v_exp_f32 v129, v129
    v_smfmac_f32_32x32x32_bf16 v[160:175], v[96:99], v[152:159], v7
    v_exp_f32 v130, v130
    v_exp_f32 v131, v131
    v_exp_f32 v132, v132
    s_waitcnt lgkmcnt(0)
    v_mfma_f32_32x32x16_bf16 v[144:159], v[116:119], v[112:115], 0
    v_exp_f32 v133, v133
    v_exp_f32 v134, v134
    v_exp_f32 v135, v135
    v_exp_f32 v136, v136
    v_exp_f32 v137, v137
    v_smfmac_f32_32x32x32_bf16 v[160:175], v[120:123], v[128:135], v7
    ds_read_b128 v[116:119], v2 offset:4096
    ds_read_b128 v[120:123], v3 offset:3072
    ds_read_b128 v[96:99], v3 offset:3584
    v_exp_f32 v138, v138
    v_exp_f32 v139, v139
    v_exp_f32 v140, v140
    v_exp_f32 v141, v141
    v_exp_f32 v142, v142
    v_exp_f32 v143, v143
    s_add_u32 m0, s96, 98304
    s_add_u32 s47, s95, 0x20c000
    buffer_load_dwordx4 v2, s[36:39], s47 offen sc1 lds
    buffer_load_dwordx4 v2, s[36:39], s47 offen offset:1024 sc1 lds
    v_exp_f32 v144, v144
    v_exp_f32 v145, v145
    v_smfmac_f32_32x32x32_bf16 v[160:175], v[124:127], v[136:143], v7
    v_exp_f32 v146, v146
    v_exp_f32 v147, v147
    v_exp_f32 v148, v148
    s_waitcnt lgkmcnt(0)
    v_mfma_f32_32x32x16_bf16 v[128:143], v[116:119], v[112:115], 0
    v_exp_f32 v149, v149
    v_exp_f32 v150, v150
    v_exp_f32 v151, v151
    v_exp_f32 v152, v152
    v_exp_f32 v153, v153
    v_smfmac_f32_32x32x32_bf16 v[160:175], v[120:123], v[144:151], v7
    ds_read_b128 v[116:119], v2 offset:5120
    v_add_u32 v3, v4, v3
    ds_read_b128 v[120:123], v3 offset:0
    ds_read_b128 v[124:127], v3 offset:512
    v_exp_f32 v154, v154
    v_exp_f32 v155, v155
    v_exp_f32 v156, v156
    v_exp_f32 v157, v157
    v_exp_f32 v158, v158
    v_exp_f32 v159, v159
    s_waitcnt vmcnt(6)
    s_barrier
    v_mov_b32 v28, 3
    buffer_store_dword v28, v31, s[36:39], s97 offen sc1
    v_bfe_u32 v26, v2, 4, 6
    v_and_b32 v28, 15, v26
    s_lshr_b32 s65, s93, 1
    v_mov_b32 v27, s65
    v_lshrrev_b32 v29, 2, v27
    v_lshrrev_b32 v25, 3, v28
    v_lshl_add_u32 v29, v25, 2, v29
    v_and_b32 v25, 3, v27
    v_lshl_add_u32 v29, v25, 3, v29
    v_and_b32 v25, 7, v28
    v_lshl_add_u32 v29, v25, 5, v29
    v_bfe_u32 v27, v26, 1, 4
    v_and_b32 v28, 1, v26
    s_lshl_b32 s65, s94, 1
    v_add_u32 v28, s65, v28
    v_lshl_add_u32 v28, v27, 4, v28
    v_cmp_gt_u32 vcc, 32, v26
    s_nop 1
    v_cndmask_b32 v29, v28, v29, vcc
    v_lshlrev_b32 v29, 7, v29
    v_add_u32 v29, 0xb00000, v29
    s_cmp_eq_u32 s40, 0
    s_cselect_b32 s65, 0, 0x40000000
    v_add_u32 v29, s65, v29
    v_exp_f32 v128, v128
    v_exp_f32 v129, v129
    v_smfmac_f32_32x32x32_bf16 v[160:175], v[96:99], v[152:159], v7
    v_exp_f32 v130, v130
    v_exp_f32 v131, v131
    v_exp_f32 v132, v132
    s_waitcnt lgkmcnt(0)
    v_mfma_f32_32x32x16_bf16 v[144:159], v[116:119], v[112:115], 0
    v_exp_f32 v133, v133
    v_exp_f32 v134, v134
    v_exp_f32 v135, v135
    v_exp_f32 v136, v136
    v_exp_f32 v137, v137
    v_smfmac_f32_32x32x32_bf16 v[160:175], v[120:123], v[128:135], v7
    ds_read_b128 v[116:119], v2 offset:6144
    ds_read_b128 v[120:123], v3 offset:1024
    ds_read_b128 v[96:99], v3 offset:1536
    v_exp_f32 v138, v138
    v_exp_f32 v139, v139
    v_exp_f32 v140, v140
    v_exp_f32 v141, v141
    v_exp_f32 v142, v142
    v_exp_f32 v143, v143
    s_add_u32 m0, s96, 114688
    s_add_u32 s47, s95, 0x40c000
    buffer_load_dwordx4 v2, s[36:39], s47 offen sc1 lds
    buffer_load_dwordx4 v2, s[36:39], s47 offen offset:1024 sc1 lds
    v_exp_f32 v144, v144
    v_exp_f32 v145, v145
    v_smfmac_f32_32x32x32_bf16 v[160:175], v[124:127], v[136:143], v7
    v_exp_f32 v146, v146
    v_exp_f32 v147, v147
    v_exp_f32 v148, v148
    s_waitcnt lgkmcnt(0)
    v_mfma_f32_32x32x16_bf16 v[128:143], v[116:119], v[112:115], 0
    v_exp_f32 v149, v149
    v_exp_f32 v150, v150
    v_exp_f32 v151, v151
    v_exp_f32 v152, v152
    v_exp_f32 v153, v153
    v_smfmac_f32_32x32x32_bf16 v[160:175], v[120:123], v[144:151], v7
    ds_read_b128 v[116:119], v2 offset:7168
    ds_read_b128 v[120:123], v3 offset:2048
    ds_read_b128 v[124:127], v3 offset:2560
    v_exp_f32 v154, v154
    v_exp_f32 v155, v155
    v_exp_f32 v156, v156
    v_exp_f32 v157, v157
    v_exp_f32 v158, v158
    v_exp_f32 v159, v159
    buffer_load_dword v30, v29, s[36:39], 0 offen sc1
    v_exp_f32 v128, v128
    v_exp_f32 v129, v129
    v_smfmac_f32_32x32x32_bf16 v[160:175], v[96:99], v[152:159], v7
    v_exp_f32 v130, v130
    v_exp_f32 v131, v131
    v_exp_f32 v132, v132
    s_waitcnt lgkmcnt(0)
    v_mfma_f32_32x32x16_bf16 v[144:159], v[116:119], v[112:115], 0
    v_exp_f32 v133, v133
    v_exp_f32 v134, v134
    v_exp_f32 v135, v135
    v_exp_f32 v136, v136
    v_exp_f32 v137, v137
    v_smfmac_f32_32x32x32_bf16 v[160:175], v[120:123], v[128:135], v7
    ds_read_b128 v[116:119], v2 offset:8192
    ds_read_b128 v[120:123], v3 offset:3072
    ds_read_b128 v[96:99], v3 offset:3584
    v_exp_f32 v138, v138
    v_exp_f32 v139, v139
    v_exp_f32 v140, v140
    v_exp_f32 v141, v141
    v_exp_f32 v142, v142
    v_exp_f32 v143, v143
    v_exp_f32 v144, v144
    v_exp_f32 v145, v145
    v_smfmac_f32_32x32x32_bf16 v[160:175], v[124:127], v[136:143], v7
    v_exp_f32 v146, v146
    v_exp_f32 v147, v147
    v_exp_f32 v148, v148
    s_waitcnt lgkmcnt(0)
    v_mfma_f32_32x32x16_bf16 v[128:143], v[116:119], v[112:115], 0
    v_exp_f32 v149, v149
    v_exp_f32 v150, v150
    v_exp_f32 v151, v151
    v_exp_f32 v152, v152
    v_exp_f32 v153, v153
    v_smfmac_f32_32x32x32_bf16 v[160:175], v[120:123], v[144:151], v7
    ds_read_b128 v[116:119], v2 offset:9216
    v_add_u32 v3, v4, v3
    ds_read_b128 v[120:123], v3 offset:0
    ds_read_b128 v[124:127], v3 offset:512
    v_exp_f32 v154, v154
    v_exp_f32 v155, v155
    v_exp_f32 v156, v156
    v_exp_f32 v157, v157
    v_exp_f32 v158, v158
    v_exp_f32 v159, v159
    s_waitcnt vmcnt(1)
    s_waitcnt vmcnt(0)
    s_cmp_lg_u32 s40, 0
    s_cbranch_scc1 L_ok4
    v_and_b32 v30, 2, v30
    v_cmp_ne_u32 vcc, 2, v30
    s_nop 4
    s_cbranch_vccz L_ok4
    s_mov_b32 s98, 0
L_spin4:
    buffer_load_dword v30, v29, s[36:39], 0 offen sc1
    s_waitcnt vmcnt(0)
    v_and_b32 v30, 2, v30
    v_cmp_ne_u32 vcc, 2, v30
    s_add_u32 s98, s98, 1
    s_cmp_gt_u32 s98, 200000
    s_cbranch_scc1 L_ok4
    s_nop 1
    s_cbranch_vccnz L_spin4
L_ok4:
    s_barrier
    v_exp_f32 v128, v128
    v_exp_f32 v129, v129
    v_smfmac_f32_32x32x32_bf16 v[160:175], v[96:99], v[152:159], v7
    v_exp_f32 v130, v130
    v_exp_f32 v131, v131
    v_exp_f32 v132, v132
    s_waitcnt lgkmcnt(0)
    v_mfma_f32_32x32x16_bf16 v[144:159], v[116:119], v[112:115], 0
    v_exp_f32 v133, v133
    v_exp_f32 v134, v134
    v_exp_f32 v135, v135
    v_exp_f32 v136, v136
    v_exp_f32 v137, v137
    v_smfmac_f32_32x32x32_bf16 v[160:175], v[120:123], v[128:135], v7
    ds_read_b128 v[116:119], v2 offset:10240
    ds_read_b128 v[120:123], v3 offset:1024
    ds_read_b128 v[96:99], v3 offset:1536
    v_exp_f32 v138, v138
    v_exp_f32 v139, v139
    v_exp_f32 v140, v140
    v_exp_f32 v141, v141
    buffer_load_dwordx4 v[208:211], v2, s[36:39], s45 offen sc1
    buffer_load_dwordx4 v[212:215], v2, s[36:39], s46 offen sc1
    buffer_load_dwordx4 v[216:219], v2, s[36:39], s44 offen sc1
    v_exp_f32 v142, v142
    v_exp_f32 v143, v143
    v_exp_f32 v144, v144
    v_exp_f32 v145, v145
    v_smfmac_f32_32x32x32_bf16 v[160:175], v[124:127], v[136:143], v7
    v_exp_f32 v146, v146
    v_exp_f32 v147, v147
    v_exp_f32 v148, v148
    s_waitcnt lgkmcnt(0)
    v_mfma_f32_32x32x16_bf16 v[128:143], v[116:119], v[112:115], 0
    v_exp_f32 v149, v149
    v_exp_f32 v150, v150
    v_exp_f32 v151, v151
    v_exp_f32 v152, v152
    v_exp_f32 v153, v153
    v_smfmac_f32_32x32x32_bf16 v[160:175], v[120:123], v[144:151], v7
    ds_read_b128 v[116:119], v2 offset:11264
    ds_read_b128 v[120:123], v3 offset:2048
    ds_read_b128 v[124:127], v3 offset:2560
    v_exp_f32 v154, v154
    v_exp_f32 v155, v155
    v_exp_f32 v156, v156
    v_exp_f32 v157, v157
    buffer_load_dwordx4 v[220:223], v2, s[36:39], s45 offen offset:1024 sc1
    s_add_u32 s45, s45, 2048
    buffer_load_dwordx4 v[224:227], v2, s[36:39], s46 offen offset:1024 sc1
    s_add_u32 s46, s46, 2048
    buffer_load_dwordx4 v[228:231], v2, s[36:39], s44 offen offset:1024 sc1
    s_add_u32 s44, s44, 2048
    v_exp_f32 v158, v158
    v_exp_f32 v159, v159
    v_exp_f32 v128, v128
    v_exp_f32 v129, v129
    v_smfmac_f32_32x32x32_bf16 v[160:175], v[96:99], v[152:159], v7
    v_exp_f32 v130, v130
    v_exp_f32 v131, v131
    v_exp_f32 v132, v132
    s_waitcnt lgkmcnt(0)
    v_mfma_f32_32x32x16_bf16 v[144:159], v[116:119], v[112:115], 0
    v_exp_f32 v133, v133
    v_exp_f32 v134, v134
    v_exp_f32 v135, v135
    v_exp_f32 v136, v136
    v_exp_f32 v137, v137
    v_smfmac_f32_32x32x32_bf16 v[160:175], v[120:123], v[128:135], v7
    ds_read_b128 v[116:119], v2 offset:12288
    ds_read_b128 v[120:123], v3 offset:3072
    ds_read_b128 v[96:99], v3 offset:3584
    v_exp_f32 v138, v138
    v_exp_f32 v139, v139
    v_exp_f32 v140, v140
    v_exp_f32 v141, v141
    buffer_load_dwordx4 v[232:235], v2, s[36:39], s45 offen sc1
    buffer_load_dwordx4 v[236:239], v2, s[36:39], s46 offen sc1
    buffer_load_dwordx4 v[240:243], v2, s[36:39], s44 offen sc1
    v_exp_f32 v142, v142
    v_exp_f32 v143, v143
    v_exp_f32 v144, v144
    v_exp_f32 v145, v145
    v_smfmac_f32_32x32x32_bf16 v[160:175], v[124:127], v[136:143], v7
    v_exp_f32 v146, v146
    v_exp_f32 v147, v147
    v_exp_f32 v148, v148
    s_waitcnt lgkmcnt(0)
    v_mfma_f32_32x32x16_bf16 v[128:143], v[116:119], v[112:115], 0
    v_exp_f32 v149, v149
    v_exp_f32 v150, v150
    v_exp_f32 v151, v151
    v_exp_f32 v152, v152
    v_exp_f32 v153, v153
    v_smfmac_f32_32x32x32_bf16 v[160:175], v[120:123], v[144:151], v7
    ds_read_b128 v[116:119], v2 offset:13312
    v_add_u32 v3, v4, v3
    ds_read_b128 v[120:123], v3 offset:0
    ds_read_b128 v[124:127], v3 offset:512
    v_exp_f32 v154, v154
    v_exp_f32 v155, v155
    v_exp_f32 v156, v156
    v_exp_f32 v157, v157
    buffer_load_dwordx4 v[244:247], v2, s[36:39], s45 offen offset:1024 sc1
    s_add_u32 s45, s45, 2048
    buffer_load_dwordx4 v[248:251], v2, s[36:39], s46 offen offset:1024 sc1
    s_add_u32 s46, s46, 2048
    buffer_load_dwordx4 v[252:255], v2, s[36:39], s44 offen offset:1024 sc1
    s_add_u32 s44, s44, 2048
    v_exp_f32 v158, v158
    v_exp_f32 v159, v159
    v_exp_f32 v128, v128
    v_exp_f32 v129, v129
    v_smfmac_f32_32x32x32_bf16 v[160:175], v[96:99], v[152:159], v7
    v_exp_f32 v130, v130
    v_exp_f32 v131, v131
    v_exp_f32 v132, v132
    s_waitcnt lgkmcnt(0)
    v_mfma_f32_32x32x16_bf16 v[144:159], v[116:119], v[112:115], 0
    v_exp_f32 v133, v133
    v_exp_f32 v134, v134
    v_exp_f32 v135, v135
    v_exp_f32 v136, v136
    v_exp_f32 v137, v137
    v_smfmac_f32_32x32x32_bf16 v[160:175], v[120:123], v[128:135], v7
    ds_read_b128 v[116:119], v2 offset:14336
    ds_read_b128 v[120:123], v3 offset:1024
    ds_read_b128 v[96:99], v3 offset:1536
    v_exp_f32 v138, v138
    v_exp_f32 v139, v139
    v_exp_f32 v140, v140
    v_exp_f32 v141, v141
    s_waitcnt vmcnt(6)
    v_mfma_f32_32x32x16_bf16 v[176:191], v[212:215], v[208:211], 0
    buffer_load_dwordx4 v[32:35], v2, s[36:39], s45 offen sc1
    buffer_load_dwordx4 v[36:39], v2, s[36:39], s46 offen sc1
    v_exp_f32 v142, v142
    v_exp_f32 v143, v143
    v_exp_f32 v144, v144
    v_exp_f32 v145, v145
    v_smfmac_f32_32x32x32_bf16 v[160:175], v[124:127], v[136:143], v7
    v_exp_f32 v146, v146
    v_exp_f32 v147, v147
    v_exp_f32 v148, v148
    s_waitcnt lgkmcnt(0)
    v_mfma_f32_32x32x16_bf16 v[128:143], v[116:119], v[112:115], 0
    v_exp_f32 v149, v149
    v_exp_f32 v150, v150
    v_exp_f32 v151, v151
    v_exp_f32 v152, v152
    v_exp_f32 v153, v153
    v_smfmac_f32_32x32x32_bf16 v[160:175], v[120:123], v[144:151], v7
    ds_read_b128 v[116:119], v2 offset:15360
    ds_read_b128 v[120:123], v3 offset:2048
    ds_read_b128 v[124:127], v3 offset:2560
    v_exp_f32 v154, v154
    v_exp_f32 v155, v155
    v_exp_f32 v156, v156
    v_exp_f32 v157, v157
    v_mfma_f32_32x32x16_bf16 v[192:207], v[216:219], v[208:211], 0
    buffer_load_dwordx4 v[40:43], v2, s[36:39], s44 offen sc1
    buffer_load_dwordx4 v[44:47], v2, s[36:39], s45 offen offset:1024 sc1
    s_add_u32 s45, s45, 2048
    v_exp_f32 v158, v158
    v_exp_f32 v159, v159
    v_exp_f32 v128, v128
    v_exp_f32 v129, v129
    v_smfmac_f32_32x32x32_bf16 v[160:175], v[96:99], v[152:159], v7
    v_exp_f32 v130, v130
    v_exp_f32 v131, v131
    v_exp_f32 v132, v132
    s_waitcnt lgkmcnt(0)
    v_mfma_f32_32x32x16_bf16 v[144:159], v[116:119], v[112:115], 0
    v_exp_f32 v133, v133
    v_exp_f32 v134, v134
    v_exp_f32 v135, v135
    v_exp_f32 v136, v136
    v_exp_f32 v137, v137
    v_smfmac_f32_32x32x32_bf16 v[160:175], v[120:123], v[128:135], v7
    ds_read_b128 v[116:119], v2 offset:32768
    ds_read_b128 v[120:123], v3 offset:3072
    ds_read_b128 v[96:99], v3 offset:3584
    v_exp_f32 v138, v138
    v_exp_f32 v139, v139
    v_exp_f32 v140, v140
    v_exp_f32 v141, v141
    v_mfma_f32_32x32x16_bf16 v[176:191], v[224:227], v[220:223], v[176:191]
    buffer_load_dwordx4 v[48:51], v2, s[36:39], s46 offen offset:1024 sc1
    s_add_u32 s46, s46, 2048
    v_exp_f32 v142, v142
    v_exp_f32 v143, v143
    v_exp_f32 v144, v144
    v_exp_f32 v145, v145
    v_smfmac_f32_32x32x32_bf16 v[160:175], v[124:127], v[136:143], v7
    v_exp_f32 v146, v146
    v_exp_f32 v147, v147
    v_exp_f32 v148, v148
    s_waitcnt lgkmcnt(0)
    v_mfma_f32_32x32x16_bf16 v[128:143], v[116:119], v[112:115], 0
    v_exp_f32 v149, v149
    v_exp_f32 v150, v150
    v_exp_f32 v151, v151
    v_exp_f32 v152, v152
    v_exp_f32 v153, v153
    v_smfmac_f32_32x32x32_bf16 v[160:175], v[120:123], v[144:151], v7
    ds_read_b128 v[116:119], v2 offset:33792
    v_add_u32 v3, v5, v3
    ds_read_b128 v[120:123], v3 offset:0
    ds_read_b128 v[124:127], v3 offset:512
    v_exp_f32 v154, v154
    v_exp_f32 v155, v155
    v_exp_f32 v156, v156
    v_exp_f32 v157, v157
    v_mfma_f32_32x32x16_bf16 v[192:207], v[228:231], v[220:223], v[192:207]
    buffer_load_dwordx4 v[52:55], v2, s[36:39], s44 offen offset:1024 sc1
    s_add_u32 s44, s44, 2048
    v_exp_f32 v158, v158
    v_exp_f32 v159, v159
    v_exp_f32 v128, v128
    v_exp_f32 v129, v129
    v_smfmac_f32_32x32x32_bf16 v[160:175], v[96:99], v[152:159], v7
    v_exp_f32 v130, v130
    v_exp_f32 v131, v131
    v_exp_f32 v132, v132
    s_waitcnt lgkmcnt(0)
    v_mfma_f32_32x32x16_bf16 v[144:159], v[116:119], v[112:115], 0
    v_exp_f32 v133, v133
    v_exp_f32 v134, v134
    v_exp_f32 v135, v135
    v_exp_f32 v136, v136
    v_exp_f32 v137, v137
    v_smfmac_f32_32x32x32_bf16 v[160:175], v[120:123], v[128:135], v7
    ds_read_b128 v[116:119], v2 offset:34816
    ds_read_b128 v[120:123], v3 offset:1024
    ds_read_b128 v[96:99], v3 offset:1536
    v_exp_f32 v138, v138
    v_exp_f32 v139, v139
    v_exp_f32 v140, v140
    v_exp_f32 v141, v141
    s_waitcnt vmcnt(6)
    v_mfma_f32_32x32x16_bf16 v[176:191], v[236:239], v[232:235], v[176:191]
    buffer_load_dwordx4 v[208:211], v2, s[36:39], s45 offen sc1
    buffer_load_dwordx4 v[212:215], v2, s[36:39], s46 offen sc1
    v_exp_f32 v142, v142
    v_exp_f32 v143, v143
    v_exp_f32 v144, v144
    v_exp_f32 v145, v145
    v_smfmac_f32_32x32x32_bf16 v[160:175], v[124:127], v[136:143], v7
    v_exp_f32 v146, v146
    v_exp_f32 v147, v147
    v_exp_f32 v148, v148
    s_waitcnt lgkmcnt(0)
    v_mfma_f32_32x32x16_bf16 v[128:143], v[116:119], v[112:115], 0
    v_exp_f32 v149, v149
    v_exp_f32 v150, v150
    v_exp_f32 v151, v151
    v_exp_f32 v152, v152
    v_exp_f32 v153, v153
    v_smfmac_f32_32x32x32_bf16 v[160:175], v[120:123], v[144:151], v7
    ds_read_b128 v[116:119], v2 offset:35840
    ds_read_b128 v[120:123], v3 offset:2048
    ds_read_b128 v[124:127], v3 offset:2560
    v_exp_f32 v154, v154
    v_exp_f32 v155, v155
    v_exp_f32 v156, v156
    v_exp_f32 v157, v157
    v_mfma_f32_32x32x16_bf16 v[192:207], v[240:243], v[232:235], v[192:207]
    buffer_load_dwordx4 v[216:219], v2, s[36:39], s44 offen sc1
    buffer_load_dwordx4 v[220:223], v2, s[36:39], s45 offen offset:1024 sc1
    s_add_u32 s45, s45, 2048
    v_exp_f32 v158, v158
    v_exp_f32 v159, v159
    v_exp_f32 v128, v128
    v_exp_f32 v129, v129
    v_smfmac_f32_32x32x32_bf16 v[160:175], v[96:99], v[152:159], v7
    v_exp_f32 v130, v130
    v_exp_f32 v131, v131
    v_exp_f32 v132, v132
    s_waitcnt lgkmcnt(0)
    v_mfma_f32_32x32x16_bf16 v[144:159], v[116:119], v[112:115], 0
    v_exp_f32 v133, v133
    v_exp_f32 v134, v134
    v_exp_f32 v135, v135
    v_exp_f32 v136, v136
    v_exp_f32 v137, v137
    v_smfmac_f32_32x32x32_bf16 v[160:175], v[120:123], v[128:135], v7
    ds_read_b128 v[116:119], v2 offset:36864
    ds_read_b128 v[120:123], v3 offset:3072
    ds_read_b128 v[96:99], v3 offset:3584
    v_exp_f32 v138, v138
    v_exp_f32 v139, v139
    v_exp_f32 v140, v140
    v_exp_f32 v141, v141
    v_mfma_f32_32x32x16_bf16 v[176:191], v[248:251], v[244:247], v[176:191]
    buffer_load_dwordx4 v[224:227], v2, s[36:39], s46 offen offset:1024 sc1
    s_add_u32 s46, s46, 2048
    v_exp_f32 v142, v142
    v_exp_f32 v143, v143
    v_exp_f32 v144, v144
    v_exp_f32 v145, v145
    v_smfmac_f32_32x32x32_bf16 v[160:175], v[124:127], v[136:143], v7
    v_exp_f32 v146, v146
    v_exp_f32 v147, v147
    v_exp_f32 v148, v148
    s_waitcnt lgkmcnt(0)
    v_mfma_f32_32x32x16_bf16 v[128:143], v[116:119], v[112:115], 0
    v_exp_f32 v149, v149
    v_exp_f32 v150, v150
    v_exp_f32 v151, v151
    v_exp_f32 v152, v152
    v_exp_f32 v153, v153
    v_smfmac_f32_32x32x32_bf16 v[160:175], v[120:123], v[144:151], v7
    ds_read_b128 v[116:119], v2 offset:37888
    v_add_u32 v3, v4, v3
    ds_read_b128 v[120:123], v3 offset:0
    ds_read_b128 v[124:127], v3 offset:512
    v_exp_f32 v154, v154
    v_exp_f32 v155, v155
    v_exp_f32 v156, v156
    v_exp_f32 v157, v157
    v_mfma_f32_32x32x16_bf16 v[192:207], v[252:255], v[244:247], v[192:207]
    buffer_load_dwordx4 v[228:231], v2, s[36:39], s44 offen offset:1024 sc1
    s_add_u32 s44, s44, 2048
    v_exp_f32 v158, v158
    v_exp_f32 v159, v159
    v_exp_f32 v128, v128
    v_exp_f32 v129, v129
    v_smfmac_f32_32x32x32_bf16 v[160:175], v[96:99], v[152:159], v7
    v_exp_f32 v130, v130
    v_exp_f32 v131, v131
    v_exp_f32 v132, v132
    s_waitcnt lgkmcnt(0)
    v_mfma_f32_32x32x16_bf16 v[144:159], v[116:119], v[112:115], 0
    v_exp_f32 v133, v133
    v_exp_f32 v134, v134
    v_exp_f32 v135, v135
    v_exp_f32 v136, v136
    v_exp_f32 v137, v137
    v_smfmac_f32_32x32x32_bf16 v[160:175], v[120:123], v[128:135], v7
    ds_read_b128 v[116:119], v2 offset:38912
    ds_read_b128 v[120:123], v3 offset:1024
    ds_read_b128 v[96:99], v3 offset:1536
    v_exp_f32 v138, v138
    v_exp_f32 v139, v139
    v_exp_f32 v140, v140
    v_exp_f32 v141, v141
    s_waitcnt vmcnt(6)
    v_mfma_f32_32x32x16_bf16 v[176:191], v[36:39], v[32:35], v[176:191]
    buffer_load_dwordx4 v[232:235], v2, s[36:39], s45 offen sc1
    buffer_load_dwordx4 v[236:239], v2, s[36:39], s46 offen sc1
    v_exp_f32 v142, v142
    v_exp_f32 v143, v143
    v_exp_f32 v144, v144
    v_exp_f32 v145, v145
    v_smfmac_f32_32x32x32_bf16 v[160:175], v[124:127], v[136:143], v7
    v_exp_f32 v146, v146
    v_exp_f32 v147, v147
    v_exp_f32 v148, v148
    s_waitcnt lgkmcnt(0)
    v_mfma_f32_32x32x16_bf16 v[128:143], v[116:119], v[112:115], 0
    v_exp_f32 v149, v149
    v_exp_f32 v150, v150
    v_exp_f32 v151, v151
    v_exp_f32 v152, v152
    v_exp_f32 v153, v153
    v_smfmac_f32_32x32x32_bf16 v[160:175], v[120:123], v[144:151], v7
    ds_read_b128 v[116:119], v2 offset:39936
    ds_read_b128 v[120:123], v3 offset:2048
    ds_read_b128 v[124:127], v3 offset:2560
    v_exp_f32 v154, v154
    v_exp_f32 v155, v155
    v_exp_f32 v156, v156
    v_exp_f32 v157, v157
    v_mfma_f32_32x32x16_bf16 v[192:207], v[40:43], v[32:35], v[192:207]
    buffer_load_dwordx4 v[240:243], v2, s[36:39], s44 offen sc1
    buffer_load_dwordx4 v[244:247], v2, s[36:39], s45 offen offset:1024 sc1
    s_add_u32 s45, s45, 2048
    v_exp_f32 v158, v158
    v_exp_f32 v159, v159
    v_exp_f32 v128, v128
    v_exp_f32 v129, v129
    v_smfmac_f32_32x32x32_bf16 v[160:175], v[96:99], v[152:159], v7
    v_exp_f32 v130, v130
    v_exp_f32 v131, v131
    v_exp_f32 v132, v132
    s_waitcnt lgkmcnt(0)
    v_mfma_f32_32x32x16_bf16 v[144:159], v[116:119], v[112:115], 0
    v_exp_f32 v133, v133
    v_exp_f32 v134, v134
    v_exp_f32 v135, v135
    v_exp_f32 v136, v136
    v_exp_f32 v137, v137
    v_smfmac_f32_32x32x32_bf16 v[160:175], v[120:123], v[128:135], v7
    ds_read_b128 v[116:119], v2 offset:40960
    ds_read_b128 v[120:123], v3 offset:3072
    ds_read_b128 v[96:99], v3 offset:3584
    v_exp_f32 v138, v138
    v_exp_f32 v139, v139
    v_exp_f32 v140, v140
    v_exp_f32 v141, v141
    v_mfma_f32_32x32x16_bf16 v[176:191], v[48:51], v[44:47], v[176:191]
    buffer_load_dwordx4 v[248:251], v2, s[36:39], s46 offen offset:1024 sc1
    s_add_u32 s46, s46, 2048
    v_exp_f32 v142, v142
    v_exp_f32 v143, v143
    v_exp_f32 v144, v144
    v_exp_f32 v145, v145
    v_smfmac_f32_32x32x32_bf16 v[160:175], v[124:127], v[136:143], v7
    v_exp_f32 v146, v146
    v_exp_f32 v147, v147
    v_exp_f32 v148, v148
    s_waitcnt lgkmcnt(0)
    v_mfma_f32_32x32x16_bf16 v[128:143], v[116:119], v[112:115], 0
    v_exp_f32 v149, v149
    v_exp_f32 v150, v150
    v_exp_f32 v151, v151
    v_exp_f32 v152, v152
    v_exp_f32 v153, v153
    v_smfmac_f32_32x32x32_bf16 v[160:175], v[120:123], v[144:151], v7
    ds_read_b128 v[116:119], v2 offset:41984
    v_add_u32 v3, v4, v3
    ds_read_b128 v[120:123], v3 offset:0
    ds_read_b128 v[124:127], v3 offset:512
    v_exp_f32 v154, v154
    v_exp_f32 v155, v155
    v_exp_f32 v156, v156
    v_exp_f32 v157, v157
    v_mfma_f32_32x32x16_bf16 v[192:207], v[52:55], v[44:47], v[192:207]
    buffer_load_dwordx4 v[252:255], v2, s[36:39], s44 offen offset:1024 sc1
    s_add_u32 s44, s44, 2048
    v_exp_f32 v158, v158
    v_exp_f32 v159, v159
    v_exp_f32 v128, v128
    v_exp_f32 v129, v129
    v_smfmac_f32_32x32x32_bf16 v[160:175], v[96:99], v[152:159], v7
    v_exp_f32 v130, v130
    v_exp_f32 v131, v131
    v_exp_f32 v132, v132
    s_waitcnt lgkmcnt(0)
    v_mfma_f32_32x32x16_bf16 v[144:159], v[116:119], v[112:115], 0
    v_exp_f32 v133, v133
    v_exp_f32 v134, v134
    v_exp_f32 v135, v135
    v_exp_f32 v136, v136
    v_exp_f32 v137, v137
    v_smfmac_f32_32x32x32_bf16 v[160:175], v[120:123], v[128:135], v7
    ds_read_b128 v[116:119], v2 offset:43008
    ds_read_b128 v[120:123], v3 offset:1024
    ds_read_b128 v[96:99], v3 offset:1536
    v_exp_f32 v138, v138
    v_exp_f32 v139, v139
    v_exp_f32 v140, v140
    v_exp_f32 v141, v141
    s_waitcnt vmcnt(6)
    v_mfma_f32_32x32x16_bf16 v[176:191], v[212:215], v[208:211], v[176:191]
    buffer_load_dwordx4 v[32:35], v2, s[36:39], s45 offen sc1
    buffer_load_dwordx4 v[36:39], v2, s[36:39], s46 offen sc1
    v_exp_f32 v142, v142
    v_exp_f32 v143, v143
    v_exp_f32 v144, v144
    v_exp_f32 v145, v145
    v_smfmac_f32_32x32x32_bf16 v[160:175], v[124:127], v[136:143], v7
    v_exp_f32 v146, v146
    v_exp_f32 v147, v147
    v_exp_f32 v148, v148
    s_waitcnt lgkmcnt(0)
    v_mfma_f32_32x32x16_bf16 v[128:143], v[116:119], v[112:115], 0
    v_exp_f32 v149, v149
    v_exp_f32 v150, v150
    v_exp_f32 v151, v151
    v_exp_f32 v152, v152
    v_exp_f32 v153, v153
    v_smfmac_f32_32x32x32_bf16 v[160:175], v[120:123], v[144:151], v7
    ds_read_b128 v[116:119], v2 offset:44032
    ds_read_b128 v[120:123], v3 offset:2048
    ds_read_b128 v[124:127], v3 offset:2560
    v_exp_f32 v154, v154
    v_exp_f32 v155, v155
    v_exp_f32 v156, v156
    v_exp_f32 v157, v157
    v_mfma_f32_32x32x16_bf16 v[192:207], v[216:219], v[208:211], v[192:207]
    buffer_load_dwordx4 v[40:43], v2, s[36:39], s44 offen sc1
    buffer_load_dwordx4 v[44:47], v2, s[36:39], s45 offen offset:1024 sc1
    s_add_u32 s45, s45, 2048
    v_exp_f32 v158, v158
    v_exp_f32 v159, v159
    v_exp_f32 v128, v128
    v_exp_f32 v129, v129
    v_smfmac_f32_32x32x32_bf16 v[160:175], v[96:99], v[152:159], v7
    v_exp_f32 v130, v130
    v_exp_f32 v131, v131
    v_exp_f32 v132, v132
    s_waitcnt lgkmcnt(0)
    v_mfma_f32_32x32x16_bf16 v[144:159], v[116:119], v[112:115], 0
    v_exp_f32 v133, v133
    v_exp_f32 v134, v134
    v_exp_f32 v135, v135
    v_exp_f32 v136, v136
    v_exp_f32 v137, v137
    v_smfmac_f32_32x32x32_bf16 v[160:175], v[120:123], v[128:135], v7
    ds_read_b128 v[116:119], v2 offset:45056
    ds_read_b128 v[120:123], v3 offset:3072
    ds_read_b128 v[96:99], v3 offset:3584
    v_exp_f32 v138, v138
    v_exp_f32 v139, v139
    v_exp_f32 v140, v140
    v_exp_f32 v141, v141
    v_mfma_f32_32x32x16_bf16 v[176:191], v[224:227], v[220:223], v[176:191]
    buffer_load_dwordx4 v[48:51], v2, s[36:39], s46 offen offset:1024 sc1
    s_add_u32 s46, s46, 2048
    v_exp_f32 v142, v142
    v_exp_f32 v143, v143
    v_exp_f32 v144, v144
    v_exp_f32 v145, v145
    v_smfmac_f32_32x32x32_bf16 v[160:175], v[124:127], v[136:143], v7
    v_exp_f32 v146, v146
    v_exp_f32 v147, v147
    v_exp_f32 v148, v148
    s_waitcnt lgkmcnt(0)
    v_mfma_f32_32x32x16_bf16 v[128:143], v[116:119], v[112:115], 0
    v_exp_f32 v149, v149
    v_exp_f32 v150, v150
    v_exp_f32 v151, v151
    v_exp_f32 v152, v152
    v_exp_f32 v153, v153
    v_smfmac_f32_32x32x32_bf16 v[160:175], v[120:123], v[144:151], v7
    ds_read_b128 v[116:119], v2 offset:46080
    v_add_u32 v3, v4, v3
    ds_read_b128 v[120:123], v3 offset:0
    ds_read_b128 v[124:127], v3 offset:512
    v_exp_f32 v154, v154
    v_exp_f32 v155, v155
    v_exp_f32 v156, v156
    v_exp_f32 v157, v157
    v_mfma_f32_32x32x16_bf16 v[192:207], v[228:231], v[220:223], v[192:207]
    buffer_load_dwordx4 v[52:55], v2, s[36:39], s44 offen offset:1024 sc1
    s_add_u32 s44, s44, 2048
    v_exp_f32 v158, v158
    v_exp_f32 v159, v159
    v_exp_f32 v128, v128
    v_exp_f32 v129, v129
    v_smfmac_f32_32x32x32_bf16 v[160:175], v[96:99], v[152:159], v7
    v_exp_f32 v130, v130
    v_exp_f32 v131, v131
    v_exp_f32 v132, v132
    s_waitcnt lgkmcnt(0)
    v_mfma_f32_32x32x16_bf16 v[144:159], v[116:119], v[112:115], 0
    v_exp_f32 v133, v133
    v_exp_f32 v134, v134
    v_exp_f32 v135, v135
    v_exp_f32 v136, v136
    v_exp_f32 v137, v137
    v_smfmac_f32_32x32x32_bf16 v[160:175], v[120:123], v[128:135], v7
    ds_read_b128 v[116:119], v2 offset:47104
    ds_read_b128 v[120:123], v3 offset:1024
    ds_read_b128 v[96:99], v3 offset:1536
    v_exp_f32 v138, v138
    v_exp_f32 v139, v139
    v_exp_f32 v140, v140
    v_exp_f32 v141, v141
    s_waitcnt vmcnt(6)
    v_mfma_f32_32x32x16_bf16 v[176:191], v[236:239], v[232:235], v[176:191]
    buffer_load_dwordx4 v[208:211], v2, s[36:39], s45 offen sc1
    buffer_load_dwordx4 v[212:215], v2, s[36:39], s46 offen sc1
    v_exp_f32 v142, v142
    v_exp_f32 v143, v143
    v_exp_f32 v144, v144
    v_exp_f32 v145, v145
    v_smfmac_f32_32x32x32_bf16 v[160:175], v[124:127], v[136:143], v7
    v_exp_f32 v146, v146
    v_exp_f32 v147, v147
    v_exp_f32 v148, v148
    s_waitcnt lgkmcnt(0)
    v_mfma_f32_32x32x16_bf16 v[128:143], v[116:119], v[112:115], 0
    v_exp_f32 v149, v149
    v_exp_f32 v150, v150
    v_exp_f32 v151, v151
    v_exp_f32 v152, v152
    v_exp_f32 v153, v153
    v_smfmac_f32_32x32x32_bf16 v[160:175], v[120:123], v[144:151], v7
    ds_read_b128 v[116:119], v2 offset:48128
    ds_read_b128 v[120:123], v3 offset:2048
    ds_read_b128 v[124:127], v3 offset:2560
    v_exp_f32 v154, v154
    v_exp_f32 v155, v155
    v_exp_f32 v156, v156
    v_exp_f32 v157, v157
    v_mfma_f32_32x32x16_bf16 v[192:207], v[240:243], v[232:235], v[192:207]
    buffer_load_dwordx4 v[216:219], v2, s[36:39], s44 offen sc1
    buffer_load_dwordx4 v[220:223], v2, s[36:39], s45 offen offset:1024 sc1
    s_add_u32 s45, s45, 2048
    v_exp_f32 v158, v158
    v_exp_f32 v159, v159
    v_exp_f32 v128, v128
    v_exp_f32 v129, v129
    v_smfmac_f32_32x32x32_bf16 v[160:175], v[96:99], v[152:159], v7
    v_exp_f32 v130, v130
    v_exp_f32 v131, v131
    v_exp_f32 v132, v132
    s_waitcnt lgkmcnt(0)
    v_mfma_f32_32x32x16_bf16 v[144:159], v[116:119], v[112:115], 0
    v_exp_f32 v133, v133
    v_exp_f32 v134, v134
    v_exp_f32 v135, v135
    v_exp_f32 v136, v136
    v_exp_f32 v137, v137
    v_smfmac_f32_32x32x32_bf16 v[160:175], v[120:123], v[128:135], v7
    ds_read_b128 v[116:119], v10 offset:0
    ds_read_b128 v[120:123], v3 offset:3072
    ds_read_b128 v[96:99], v3 offset:3584
    v_exp_f32 v138, v138
    v_exp_f32 v139, v139
    v_exp_f32 v140, v140
    v_exp_f32 v141, v141
    v_mfma_f32_32x32x16_bf16 v[176:191], v[248:251], v[244:247], v[176:191]
    buffer_load_dwordx4 v[224:227], v2, s[36:39], s46 offen offset:1024 sc1
    s_add_u32 s46, s46, 2048
    v_exp_f32 v142, v142
    v_exp_f32 v143, v143
    v_exp_f32 v144, v144
    v_exp_f32 v145, v145
    v_smfmac_f32_32x32x32_bf16 v[160:175], v[124:127], v[136:143], v7
    v_exp_f32 v146, v146
    v_exp_f32 v147, v147
    v_exp_f32 v148, v148
    s_waitcnt lgkmcnt(0)
    v_mfma_f32_32x32x16_bf16 v[128:143], v[116:119], v[112:115], 0
    v_exp_f32 v149, v149
    v_exp_f32 v150, v150
    v_exp_f32 v151, v151
    v_exp_f32 v152, v152
    v_exp_f32 v153, v153
    v_smfmac_f32_32x32x32_bf16 v[160:175], v[120:123], v[144:151], v7
    ds_read_b128 v[116:119], v10 offset:1024
    v_add_u32 v3, v5, v3
    ds_read_b128 v[120:123], v3 offset:0
    ds_read_b128 v[124:127], v3 offset:512
    v_exp_f32 v154, v154
    v_exp_f32 v155, v155
    v_exp_f32 v156, v156
    v_exp_f32 v157, v157
    v_mfma_f32_32x32x16_bf16 v[192:207], v[252:255], v[244:247], v[192:207]
    buffer_load_dwordx4 v[228:231], v2, s[36:39], s44 offen offset:1024 sc1
    s_add_u32 s44, s44, 2048
    v_exp_f32 v158, v158
    v_exp_f32 v159, v159
    v_exp_f32 v128, v128
    v_exp_f32 v129, v129
    v_smfmac_f32_32x32x32_bf16 v[160:175], v[96:99], v[152:159], v7
    v_exp_f32 v130, v130
    v_exp_f32 v131, v131
    v_exp_f32 v132, v132
    s_waitcnt lgkmcnt(0)
    v_mfma_f32_32x32x16_bf16 v[144:159], v[116:119], v[112:115], 0
    v_exp_f32 v133, v133
    v_exp_f32 v134, v134
    v_exp_f32 v135, v135
    v_exp_f32 v136, v136
    v_exp_f32 v137, v137
    v_smfmac_f32_32x32x32_bf16 v[160:175], v[120:123], v[128:135], v7
    ds_read_b128 v[116:119], v10 offset:2048
    ds_read_b128 v[120:123], v3 offset:1024
    ds_read_b128 v[96:99], v3 offset:1536
    v_exp_f32 v138, v138
    v_exp_f32 v139, v139
    v_exp_f32 v140, v140
    v_exp_f32 v141, v141
    s_waitcnt vmcnt(6)
    v_mfma_f32_32x32x16_bf16 v[176:191], v[36:39], v[32:35], v[176:191]
    buffer_load_dwordx4 v[232:235], v2, s[36:39], s45 offen sc1
    buffer_load_dwordx4 v[236:239], v2, s[36:39], s46 offen sc1
    v_exp_f32 v142, v142
    v_exp_f32 v143, v143
    v_exp_f32 v144, v144
    v_exp_f32 v145, v145
    v_smfmac_f32_32x32x32_bf16 v[160:175], v[124:127], v[136:143], v7
    v_exp_f32 v146, v146
    v_exp_f32 v147, v147
    v_exp_f32 v148, v148
    s_waitcnt lgkmcnt(0)
    v_mfma_f32_32x32x16_bf16 v[128:143], v[116:119], v[112:115], 0
    v_exp_f32 v149, v149
    v_exp_f32 v150, v150
    v_exp_f32 v151, v151
    v_exp_f32 v152, v152
    v_exp_f32 v153, v153
    v_smfmac_f32_32x32x32_bf16 v[160:175], v[120:123], v[144:151], v7
    ds_read_b128 v[116:119], v10 offset:3072
    ds_read_b128 v[120:123], v3 offset:2048
    ds_read_b128 v[124:127], v3 offset:2560
    v_exp_f32 v154, v154
    v_exp_f32 v155, v155
    v_exp_f32 v156, v156
    v_exp_f32 v157, v157
    v_mfma_f32_32x32x16_bf16 v[192:207], v[40:43], v[32:35], v[192:207]
    buffer_load_dwordx4 v[240:243], v2, s[36:39], s44 offen sc1
    buffer_load_dwordx4 v[244:247], v2, s[36:39], s45 offen offset:1024 sc1
    s_add_u32 s45, s45, 2048
    v_exp_f32 v158, v158
    v_exp_f32 v159, v159
    v_exp_f32 v128, v128
    v_exp_f32 v129, v129
    v_smfmac_f32_32x32x32_bf16 v[160:175], v[96:99], v[152:159], v7
    v_exp_f32 v130, v130
    v_exp_f32 v131, v131
    v_exp_f32 v132, v132
    s_waitcnt lgkmcnt(0)
    v_mfma_f32_32x32x16_bf16 v[144:159], v[116:119], v[112:115], 0
    v_exp_f32 v133, v133
    v_exp_f32 v134, v134
    v_exp_f32 v135, v135
    v_exp_f32 v136, v136
    v_exp_f32 v137, v137
    v_smfmac_f32_32x32x32_bf16 v[160:175], v[120:123], v[128:135], v7
    ds_read_b128 v[116:119], v10 offset:4096
    ds_read_b128 v[120:123], v3 offset:3072
    ds_read_b128 v[96:99], v3 offset:3584
    v_exp_f32 v138, v138
    v_exp_f32 v139, v139
    v_exp_f32 v140, v140
    v_exp_f32 v141, v141
    v_mfma_f32_32x32x16_bf16 v[176:191], v[48:51], v[44:47], v[176:191]
    buffer_load_dwordx4 v[248:251], v2, s[36:39], s46 offen offset:1024 sc1
    s_add_u32 s46, s46, 2048
    v_exp_f32 v142, v142
    v_exp_f32 v143, v143
    v_exp_f32 v144, v144
    v_exp_f32 v145, v145
    v_smfmac_f32_32x32x32_bf16 v[160:175], v[124:127], v[136:143], v7
    v_exp_f32 v146, v146
    v_exp_f32 v147, v147
    v_exp_f32 v148, v148
    s_waitcnt lgkmcnt(0)
    v_mfma_f32_32x32x16_bf16 v[128:143], v[116:119], v[112:115], 0
    v_exp_f32 v149, v149
    v_exp_f32 v150, v150
    v_exp_f32 v151, v151
    v_exp_f32 v152, v152
    v_exp_f32 v153, v153
    v_smfmac_f32_32x32x32_bf16 v[160:175], v[120:123], v[144:151], v7
    ds_read_b128 v[116:119], v10 offset:5120
    v_add_u32 v3, v4, v3
    ds_read_b128 v[120:123], v3 offset:0
    ds_read_b128 v[124:127], v3 offset:512
    v_exp_f32 v154, v154
    v_exp_f32 v155, v155
    v_exp_f32 v156, v156
    v_exp_f32 v157, v157
    v_mfma_f32_32x32x16_bf16 v[192:207], v[52:55], v[44:47], v[192:207]
    buffer_load_dwordx4 v[252:255], v2, s[36:39], s44 offen offset:1024 sc1
    s_add_u32 s44, s44, 2048
    v_exp_f32 v158, v158
    v_exp_f32 v159, v159
    s_barrier
    v_exp_f32 v128, v128
    v_exp_f32 v129, v129
    v_smfmac_f32_32x32x32_bf16 v[160:175], v[96:99], v[152:159], v7
    v_exp_f32 v130, v130
    v_exp_f32 v131, v131
    v_exp_f32 v132, v132
    s_waitcnt lgkmcnt(0)
    v_mfma_f32_32x32x16_bf16 v[144:159], v[116:119], v[112:115], 0
    v_exp_f32 v133, v133
    v_exp_f32 v134, v134
    v_exp_f32 v135, v135
    v_exp_f32 v136, v136
    v_exp_f32 v137, v137
    v_smfmac_f32_32x32x32_bf16 v[160:175], v[120:123], v[128:135], v7
    ds_read_b128 v[116:119], v10 offset:6144
    ds_read_b128 v[120:123], v3 offset:1024
    ds_read_b128 v[96:99], v3 offset:1536
    v_exp_f32 v138, v138
    v_exp_f32 v139, v139
    v_exp_f32 v140, v140
    v_exp_f32 v141, v141
    s_waitcnt vmcnt(6)
    v_mfma_f32_32x32x16_bf16 v[176:191], v[212:215], v[208:211], v[176:191]
    buffer_load_dwordx4 v[32:35], v2, s[36:39], s45 offen sc1
    buffer_load_dwordx4 v[36:39], v2, s[36:39], s46 offen sc1
    v_exp_f32 v142, v142
    v_exp_f32 v143, v143
    v_exp_f32 v144, v144
    v_exp_f32 v145, v145
    v_smfmac_f32_32x32x32_bf16 v[160:175], v[124:127], v[136:143], v7
    v_exp_f32 v146, v146
    v_exp_f32 v147, v147
    v_exp_f32 v148, v148
    s_waitcnt lgkmcnt(0)
    v_mfma_f32_32x32x16_bf16 v[128:143], v[116:119], v[112:115], 0
    v_exp_f32 v149, v149
    v_exp_f32 v150, v150
    v_exp_f32 v151, v151
    v_exp_f32 v152, v152
    v_exp_f32 v153, v153
    v_smfmac_f32_32x32x32_bf16 v[160:175], v[120:123], v[144:151], v7
    ds_read_b128 v[116:119], v10 offset:7168
    ds_read_b128 v[120:123], v3 offset:2048
    ds_read_b128 v[124:127], v3 offset:2560
    v_exp_f32 v154, v154
    v_exp_f32 v155, v155
    v_exp_f32 v156, v156
    v_exp_f32 v157, v157
    v_mfma_f32_32x32x16_bf16 v[192:207], v[216:219], v[208:211], v[192:207]
    buffer_load_dwordx4 v[40:43], v2, s[36:39], s44 offen sc1
    buffer_load_dwordx4 v[44:47], v2, s[36:39], s45 offen offset:1024 sc1
    s_add_u32 s45, s45, 2048
    v_exp_f32 v158, v158
    v_exp_f32 v159, v159
    v_exp_f32 v128, v128
    v_exp_f32 v129, v129
    v_smfmac_f32_32x32x32_bf16 v[160:175], v[96:99], v[152:159], v7
    v_exp_f32 v130, v130
    v_exp_f32 v131, v131
    v_exp_f32 v132, v132
    s_waitcnt lgkmcnt(0)
    v_mfma_f32_32x32x16_bf16 v[144:159], v[116:119], v[112:115], 0
    v_exp_f32 v133, v133
    v_exp_f32 v134, v134
    v_exp_f32 v135, v135
    v_exp_f32 v136, v136
    v_exp_f32 v137, v137
    v_smfmac_f32_32x32x32_bf16 v[160:175], v[120:123], v[128:135], v7
    ds_read_b128 v[116:119], v10 offset:8192
    ds_read_b128 v[120:123], v3 offset:3072
    ds_read_b128 v[96:99], v3 offset:3584
    v_exp_f32 v138, v138
    v_exp_f32 v139, v139
    v_exp_f32 v140, v140
    v_exp_f32 v141, v141
    v_mfma_f32_32x32x16_bf16 v[176:191], v[224:227], v[220:223], v[176:191]
    buffer_load_dwordx4 v[48:51], v2, s[36:39], s46 offen offset:1024 sc1
    s_add_u32 s46, s46, 2048
    v_exp_f32 v142, v142
    v_exp_f32 v143, v143
    v_exp_f32 v144, v144
    v_exp_f32 v145, v145
    v_smfmac_f32_32x32x32_bf16 v[160:175], v[124:127], v[136:143], v7
    v_exp_f32 v146, v146
    v_exp_f32 v147, v147
    v_exp_f32 v148, v148
    s_waitcnt lgkmcnt(0)
    v_mfma_f32_32x32x16_bf16 v[128:143], v[116:119], v[112:115], 0
    v_exp_f32 v149, v149
    v_exp_f32 v150, v150
    v_exp_f32 v151, v151
    v_exp_f32 v152, v152
    v_exp_f32 v153, v153
    v_smfmac_f32_32x32x32_bf16 v[160:175], v[120:123], v[144:151], v7
    ds_read_b128 v[116:119], v10 offset:9216
    v_add_u32 v3, v4, v3
    ds_read_b128 v[120:123], v3 offset:0
    ds_read_b128 v[124:127], v3 offset:512
    v_exp_f32 v154, v154
    v_exp_f32 v155, v155
    v_exp_f32 v156, v156
    v_exp_f32 v157, v157
    v_mfma_f32_32x32x16_bf16 v[192:207], v[228:231], v[220:223], v[192:207]
    buffer_load_dwordx4 v[52:55], v2, s[36:39], s44 offen offset:1024 sc1
    s_add_u32 s44, s44, 2048
    v_exp_f32 v158, v158
    v_exp_f32 v159, v159
    v_exp_f32 v128, v128
    v_exp_f32 v129, v129
    v_smfmac_f32_32x32x32_bf16 v[160:175], v[96:99], v[152:159], v7
    v_exp_f32 v130, v130
    v_exp_f32 v131, v131
    v_exp_f32 v132, v132
    s_waitcnt lgkmcnt(0)
    v_mfma_f32_32x32x16_bf16 v[144:159], v[116:119], v[112:115], 0
    v_exp_f32 v133, v133
    v_exp_f32 v134, v134
    v_exp_f32 v135, v135
    v_exp_f32 v136, v136
    v_exp_f32 v137, v137
    v_smfmac_f32_32x32x32_bf16 v[160:175], v[120:123], v[128:135], v7
    ds_read_b128 v[116:119], v10 offset:10240
    ds_read_b128 v[120:123], v3 offset:1024
    ds_read_b128 v[96:99], v3 offset:1536
    v_exp_f32 v138, v138
    v_exp_f32 v139, v139
    v_exp_f32 v140, v140
    v_exp_f32 v141, v141
    s_waitcnt vmcnt(6)
    v_mfma_f32_32x32x16_bf16 v[176:191], v[236:239], v[232:235], v[176:191]
    buffer_load_dwordx4 v[208:211], v2, s[36:39], s45 offen sc1
    buffer_load_dwordx4 v[212:215], v2, s[36:39], s46 offen sc1
    buffer_load_dwordx4 v[56:59], v2, s[36:39], s51 offen offset:0 sc1
    v_exp_f32 v142, v142
    v_exp_f32 v143, v143
    v_exp_f32 v144, v144
    v_exp_f32 v145, v145
    v_smfmac_f32_32x32x32_bf16 v[160:175], v[124:127], v[136:143], v7
    v_exp_f32 v146, v146
    v_exp_f32 v147, v147
    v_exp_f32 v148, v148
    s_waitcnt lgkmcnt(0)
    v_mfma_f32_32x32x16_bf16 v[128:143], v[116:119], v[112:115], 0
    v_exp_f32 v149, v149
    v_exp_f32 v150, v150
    v_exp_f32 v151, v151
    v_exp_f32 v152, v152
    v_exp_f32 v153, v153
    v_smfmac_f32_32x32x32_bf16 v[160:175], v[120:123], v[144:151], v7
    ds_read_b128 v[116:119], v10 offset:11264
    ds_read_b128 v[120:123], v3 offset:2048
    ds_read_b128 v[124:127], v3 offset:2560
    v_exp_f32 v154, v154
    v_exp_f32 v155, v155
    v_exp_f32 v156, v156
    v_exp_f32 v157, v157
    v_mfma_f32_32x32x16_bf16 v[192:207], v[240:243], v[232:235], v[192:207]
    buffer_load_dwordx4 v[216:219], v2, s[36:39], s44 offen sc1
    buffer_load_dwordx4 v[220:223], v2, s[36:39], s45 offen offset:1024 sc1
    s_add_u32 s45, s45, 2048
    buffer_load_dwordx4 v[60:63], v2, s[36:39], s55 offen offset:0 sc1
    v_exp_f32 v158, v158
    v_exp_f32 v159, v159
    v_exp_f32 v128, v128
    v_exp_f32 v129, v129
    v_smfmac_f32_32x32x32_bf16 v[160:175], v[96:99], v[152:159], v7
    v_exp_f32 v130, v130
    v_exp_f32 v131, v131
    v_exp_f32 v132, v132
    s_waitcnt lgkmcnt(0)
    v_mfma_f32_32x32x16_bf16 v[144:159], v[116:119], v[112:115], 0
    v_exp_f32 v133, v133
    v_exp_f32 v134, v134
    v_exp_f32 v135, v135
    v_exp_f32 v136, v136
    v_exp_f32 v137, v137
    v_smfmac_f32_32x32x32_bf16 v[160:175], v[120:123], v[128:135], v7
    ds_read_b128 v[116:119], v10 offset:12288
    ds_read_b128 v[120:123], v3 offset:3072
    ds_read_b128 v[96:99], v3 offset:3584
    v_exp_f32 v138, v138
    v_exp_f32 v139, v139
    v_exp_f32 v140, v140
    v_exp_f32 v141, v141
    v_mfma_f32_32x32x16_bf16 v[176:191], v[248:251], v[244:247], v[176:191]
    buffer_load_dwordx4 v[224:227], v2, s[36:39], s46 offen offset:1024 sc1
    s_add_u32 s46, s46, 2048
    buffer_load_dwordx4 v[64:67], v2, s[36:39], s51 offen offset:1024 sc1
    v_exp_f32 v142, v142
    v_exp_f32 v143, v143
    v_exp_f32 v144, v144
    v_exp_f32 v145, v145
    v_smfmac_f32_32x32x32_bf16 v[160:175], v[124:127], v[136:143], v7
    v_exp_f32 v146, v146
    v_exp_f32 v147, v147
    v_exp_f32 v148, v148
    s_waitcnt lgkmcnt(0)
    v_mfma_f32_32x32x16_bf16 v[128:143], v[116:119], v[112:115], 0
    v_exp_f32 v149, v149
    v_exp_f32 v150, v150
    v_exp_f32 v151, v151
    v_exp_f32 v152, v152
    v_exp_f32 v153, v153
    v_smfmac_f32_32x32x32_bf16 v[160:175], v[120:123], v[144:151], v7
    ds_read_b128 v[116:119], v10 offset:13312
    v_add_u32 v3, v4, v3
    ds_read_b128 v[120:123], v3 offset:0
    ds_read_b128 v[124:127], v3 offset:512
    v_exp_f32 v154, v154
    v_exp_f32 v155, v155
    v_exp_f32 v156, v156
    v_exp_f32 v157, v157
    v_mfma_f32_32x32x16_bf16 v[192:207], v[252:255], v[244:247], v[192:207]
    buffer_load_dwordx4 v[228:231], v2, s[36:39], s44 offen offset:1024 sc1
    s_add_u32 s44, s44, 2048
    buffer_load_dwordx4 v[68:71], v2, s[36:39], s55 offen offset:1024 sc1
    v_exp_f32 v158, v158
    v_exp_f32 v159, v159
    v_exp_f32 v128, v128
    v_exp_f32 v129, v129
    v_smfmac_f32_32x32x32_bf16 v[160:175], v[96:99], v[152:159], v7
    v_exp_f32 v130, v130
    v_exp_f32 v131, v131
    v_exp_f32 v132, v132
    s_waitcnt lgkmcnt(0)
    v_mfma_f32_32x32x16_bf16 v[144:159], v[116:119], v[112:115], 0
    v_exp_f32 v133, v133
    v_exp_f32 v134, v134
    v_exp_f32 v135, v135
    v_exp_f32 v136, v136
    v_exp_f32 v137, v137
    v_smfmac_f32_32x32x32_bf16 v[160:175], v[120:123], v[128:135], v7
    ds_read_b128 v[116:119], v10 offset:14336
    ds_read_b128 v[120:123], v3 offset:1024
    ds_read_b128 v[96:99], v3 offset:1536
    v_exp_f32 v138, v138
    v_exp_f32 v139, v139
    v_exp_f32 v140, v140
    v_exp_f32 v141, v141
    s_waitcnt vmcnt(10)
    v_mfma_f32_32x32x16_bf16 v[176:191], v[36:39], v[32:35], v[176:191]
    buffer_load_dwordx4 v[232:235], v2, s[36:39], s45 offen sc1
    buffer_load_dwordx4 v[236:239], v2, s[36:39], s46 offen sc1
    buffer_load_dwordx4 v[72:75], v2, s[36:39], s51 offen offset:2048 sc1
    v_exp_f32 v142, v142
    v_exp_f32 v143, v143
    v_exp_f32 v144, v144
    v_exp_f32 v145, v145
    v_smfmac_f32_32x32x32_bf16 v[160:175], v[124:127], v[136:143], v7
    v_exp_f32 v146, v146
    v_exp_f32 v147, v147
    v_exp_f32 v148, v148
    s_waitcnt lgkmcnt(0)
    v_mfma_f32_32x32x16_bf16 v[128:143], v[116:119], v[112:115], 0
    v_exp_f32 v149, v149
    v_exp_f32 v150, v150
    v_exp_f32 v151, v151
    v_exp_f32 v152, v152
    v_exp_f32 v153, v153
    v_smfmac_f32_32x32x32_bf16 v[160:175], v[120:123], v[144:151], v7
    ds_read_b128 v[116:119], v10 offset:15360
    ds_read_b128 v[120:123], v3 offset:2048
    ds_read_b128 v[124:127], v3 offset:2560
    v_exp_f32 v154, v154
    v_exp_f32 v155, v155
    v_exp_f32 v156, v156
    v_exp_f32 v157, v157
    v_mfma_f32_32x32x16_bf16 v[192:207], v[40:43], v[32:35], v[192:207]
    buffer_load_dwordx4 v[240:243], v2, s[36:39], s44 offen sc1
    buffer_load_dwordx4 v[244:247], v2, s[36:39], s45 offen offset:1024 sc1
    s_add_u32 s45, s45, 2048
    buffer_load_dwordx4 v[76:79], v2, s[36:39], s55 offen offset:2048 sc1
    v_exp_f32 v158, v158
    v_exp_f32 v159, v159
    v_exp_f32 v128, v128
    v_exp_f32 v129, v129
    v_smfmac_f32_32x32x32_bf16 v[160:175], v[96:99], v[152:159], v7
    v_exp_f32 v130, v130
    v_exp_f32 v131, v131
    v_exp_f32 v132, v132
    s_waitcnt lgkmcnt(0)
    v_mfma_f32_32x32x16_bf16 v[144:159], v[116:119], v[112:115], 0
    v_exp_f32 v133, v133
    v_exp_f32 v134, v134
    v_exp_f32 v135, v135
    v_exp_f32 v136, v136
    v_exp_f32 v137, v137
    v_smfmac_f32_32x32x32_bf16 v[160:175], v[120:123], v[128:135], v7
    ds_read_b128 v[116:119], v10 offset:32768
    ds_read_b128 v[120:123], v3 offset:3072
    ds_read_b128 v[96:99], v3 offset:3584
    v_exp_f32 v138, v138
    v_exp_f32 v139, v139
    v_exp_f32 v140, v140
    v_exp_f32 v141, v141
    v_mfma_f32_32x32x16_bf16 v[176:191], v[48:51], v[44:47], v[176:191]
    buffer_load_dwordx4 v[248:251], v2, s[36:39], s46 offen offset:1024 sc1
    s_add_u32 s46, s46, 2048
    buffer_load_dwordx4 v[80:83], v2, s[36:39], s51 offen offset:3072 sc1
    s_add_u32 s51, s51, 4096
    v_exp_f32 v142, v142
    v_exp_f32 v143, v143
    v_exp_f32 v144, v144
    v_exp_f32 v145, v145
    v_smfmac_f32_32x32x32_bf16 v[160:175], v[124:127], v[136:143], v7
    v_exp_f32 v146, v146
    v_exp_f32 v147, v147
    v_exp_f32 v148, v148
    s_waitcnt lgkmcnt(0)
    v_mfma_f32_32x32x16_bf16 v[128:143], v[116:119], v[112:115], 0
    v_exp_f32 v149, v149
    v_exp_f32 v150, v150
    v_exp_f32 v151, v151
    v_exp_f32 v152, v152
    v_exp_f32 v153, v153
    v_smfmac_f32_32x32x32_bf16 v[160:175], v[120:123], v[144:151], v7
    ds_read_b128 v[116:119], v10 offset:33792
    v_add_u32 v3, v5, v3
    ds_read_b128 v[120:123], v3 offset:0
    ds_read_b128 v[124:127], v3 offset:512
    v_exp_f32 v154, v154
    v_exp_f32 v155, v155
    v_exp_f32 v156, v156
    v_exp_f32 v157, v157
    v_mfma_f32_32x32x16_bf16 v[192:207], v[52:55], v[44:47], v[192:207]
    buffer_load_dwordx4 v[252:255], v2, s[36:39], s44 offen offset:1024 sc1
    s_add_u32 s44, s44, 2048
    buffer_load_dwordx4 v[84:87], v2, s[36:39], s55 offen offset:3072 sc1
    s_add_u32 s55, s55, 4096
    v_exp_f32 v158, v158
    v_exp_f32 v159, v159
    v_exp_f32 v128, v128
    v_exp_f32 v129, v129
    v_smfmac_f32_32x32x32_bf16 v[160:175], v[96:99], v[152:159], v7
    v_exp_f32 v130, v130
    v_exp_f32 v131, v131
    v_exp_f32 v132, v132
    s_waitcnt lgkmcnt(0)
    v_mfma_f32_32x32x16_bf16 v[144:159], v[116:119], v[112:115], 0
    v_exp_f32 v133, v133
    v_exp_f32 v134, v134
    v_exp_f32 v135, v135
    v_exp_f32 v136, v136
    v_exp_f32 v137, v137
    v_smfmac_f32_32x32x32_bf16 v[160:175], v[120:123], v[128:135], v7
    ds_read_b128 v[116:119], v10 offset:34816
    ds_read_b128 v[120:123], v3 offset:1024
    ds_read_b128 v[96:99], v3 offset:1536
    v_exp_f32 v138, v138
    v_exp_f32 v139, v139
    v_exp_f32 v140, v140
    v_exp_f32 v141, v141
    s_waitcnt vmcnt(11)
    v_mfma_f32_32x32x16_bf16 v[176:191], v[212:215], v[208:211], v[176:191]
    buffer_load_dwordx4 v[32:35], v2, s[36:39], s45 offen sc1
    buffer_load_dwordx4 v[36:39], v2, s[36:39], s46 offen sc1
    buffer_load_dwordx4 v[88:91], v2, s[36:39], s51 offen offset:0 sc1
    v_exp_f32 v142, v142
    v_exp_f32 v143, v143
    v_exp_f32 v144, v144
    v_exp_f32 v145, v145
    v_smfmac_f32_32x32x32_bf16 v[160:175], v[124:127], v[136:143], v7
    v_exp_f32 v146, v146
    v_exp_f32 v147, v147
    v_exp_f32 v148, v148
    s_waitcnt lgkmcnt(0)
    v_mfma_f32_32x32x16_bf16 v[128:143], v[116:119], v[112:115], 0
    v_exp_f32 v149, v149
    v_exp_f32 v150, v150
    v_exp_f32 v151, v151
    v_exp_f32 v152, v152
    v_exp_f32 v153, v153
    v_smfmac_f32_32x32x32_bf16 v[160:175], v[120:123], v[144:151], v7
    ds_read_b128 v[116:119], v10 offset:35840
    ds_read_b128 v[120:123], v3 offset:2048
    ds_read_b128 v[124:127], v3 offset:2560
    v_exp_f32 v154, v154
    v_exp_f32 v155, v155
    v_exp_f32 v156, v156
    v_exp_f32 v157, v157
    v_mfma_f32_32x32x16_bf16 v[192:207], v[216:219], v[208:211], v[192:207]
    buffer_load_dwordx4 v[40:43], v2, s[36:39], s44 offen sc1
    buffer_load_dwordx4 v[44:47], v2, s[36:39], s45 offen offset:1024 sc1
    s_add_u32 s45, s45, 2048
    buffer_load_dwordx4 v[92:95], v2, s[36:39], s55 offen offset:0 sc1
    v_exp_f32 v158, v158
    v_exp_f32 v159, v159
    v_exp_f32 v128, v128
    v_exp_f32 v129, v129
    v_smfmac_f32_32x32x32_bf16 v[160:175], v[96:99], v[152:159], v7
    v_exp_f32 v130, v130
    v_exp_f32 v131, v131
    v_exp_f32 v132, v132
    s_waitcnt lgkmcnt(0)
    v_mfma_f32_32x32x16_bf16 v[144:159], v[116:119], v[112:115], 0
    v_exp_f32 v133, v133
    v_exp_f32 v134, v134
    v_exp_f32 v135, v135
    v_exp_f32 v136, v136
    v_exp_f32 v137, v137
    v_smfmac_f32_32x32x32_bf16 v[160:175], v[120:123], v[128:135], v7
    ds_read_b128 v[116:119], v10 offset:36864
    ds_read_b128 v[120:123], v3 offset:3072
    ds_read_b128 v[96:99], v3 offset:3584
    v_exp_f32 v138, v138
    v_exp_f32 v139, v139
    v_exp_f32 v140, v140
    v_exp_f32 v141, v141
    v_mfma_f32_32x32x16_bf16 v[176:191], v[224:227], v[220:223], v[176:191]
    buffer_load_dwordx4 v[48:51], v2, s[36:39], s46 offen offset:1024 sc1
    s_add_u32 s46, s46, 2048
    buffer_load_dwordx4 v[104:107], v2, s[36:39], s51 offen offset:1024 sc1
    v_exp_f32 v142, v142
    v_exp_f32 v143, v143
    v_exp_f32 v144, v144
    v_exp_f32 v145, v145
    v_smfmac_f32_32x32x32_bf16 v[160:175], v[124:127], v[136:143], v7
    v_exp_f32 v146, v146
    v_exp_f32 v147, v147
    v_exp_f32 v148, v148
    s_waitcnt lgkmcnt(0)
    v_mfma_f32_32x32x16_bf16 v[128:143], v[116:119], v[112:115], 0
    v_exp_f32 v149, v149
    v_exp_f32 v150, v150
    v_exp_f32 v151, v151
    v_exp_f32 v152, v152
    v_exp_f32 v153, v153
    v_smfmac_f32_32x32x32_bf16 v[160:175], v[120:123], v[144:151], v7
    ds_read_b128 v[116:119], v10 offset:37888
    v_add_u32 v3, v4, v3
    ds_read_b128 v[120:123], v3 offset:0
    ds_read_b128 v[124:127], v3 offset:512
    v_exp_f32 v154, v154
    v_exp_f32 v155, v155
    v_exp_f32 v156, v156
    v_exp_f32 v157, v157
    v_mfma_f32_32x32x16_bf16 v[192:207], v[228:231], v[220:223], v[192:207]
    buffer_load_dwordx4 v[52:55], v2, s[36:39], s44 offen offset:1024 sc1
    s_add_u32 s44, s44, 2048
    buffer_load_dwordx4 v[108:111], v2, s[36:39], s55 offen offset:1024 sc1
    v_exp_f32 v158, v158
    v_exp_f32 v159, v159
    v_exp_f32 v128, v128
    v_exp_f32 v129, v129
    v_smfmac_f32_32x32x32_bf16 v[160:175], v[96:99], v[152:159], v7
    v_exp_f32 v130, v130
    v_exp_f32 v131, v131
    v_exp_f32 v132, v132
    s_waitcnt lgkmcnt(0)
    v_mfma_f32_32x32x16_bf16 v[144:159], v[116:119], v[112:115], 0
    v_exp_f32 v133, v133
    v_exp_f32 v134, v134
    v_exp_f32 v135, v135
    v_exp_f32 v136, v136
    v_exp_f32 v137, v137
    v_smfmac_f32_32x32x32_bf16 v[160:175], v[120:123], v[128:135], v7
    ds_read_b128 v[116:119], v10 offset:38912
    ds_read_b128 v[120:123], v3 offset:1024
    ds_read_b128 v[96:99], v3 offset:1536
    v_exp_f32 v138, v138
    v_exp_f32 v139, v139
    v_exp_f32 v140, v140
    v_exp_f32 v141, v141
    s_waitcnt vmcnt(11)
    v_mfma_f32_32x32x16_bf16 v[176:191], v[236:239], v[232:235], v[176:191]
    buffer_load_dwordx4 v[208:211], v2, s[36:39], s45 offen sc1
    buffer_load_dwordx4 v[212:215], v2, s[36:39], s46 offen sc1
    v_exp_f32 v142, v142
    v_exp_f32 v143, v143
    v_exp_f32 v144, v144
    v_exp_f32 v145, v145
    v_smfmac_f32_32x32x32_bf16 v[160:175], v[124:127], v[136:143], v7
    v_exp_f32 v146, v146
    v_exp_f32 v147, v147
    v_exp_f32 v148, v148
    s_waitcnt lgkmcnt(0)
    v_mfma_f32_32x32x16_bf16 v[128:143], v[116:119], v[112:115], 0
    v_exp_f32 v149, v149
    v_exp_f32 v150, v150
    v_exp_f32 v151, v151
    v_exp_f32 v152, v152
    v_exp_f32 v153, v153
    v_smfmac_f32_32x32x32_bf16 v[160:175], v[120:123], v[144:151], v7
    ds_read_b128 v[116:119], v10 offset:39936
    ds_read_b128 v[120:123], v3 offset:2048
    ds_read_b128 v[124:127], v3 offset:2560
    v_exp_f32 v154, v154
    v_exp_f32 v155, v155
    v_exp_f32 v156, v156
    v_exp_f32 v157, v157
    v_mfma_f32_32x32x16_bf16 v[192:207], v[240:243], v[232:235], v[192:207]
    buffer_load_dwordx4 v[216:219], v2, s[36:39], s44 offen sc1
    buffer_load_dwordx4 v[220:223], v2, s[36:39], s45 offen offset:1024 sc1
    s_add_u32 s45, s45, 2048
    v_exp_f32 v158, v158
    v_exp_f32 v159, v159
    v_exp_f32 v128, v128
    v_exp_f32 v129, v129
    v_smfmac_f32_32x32x32_bf16 v[160:175], v[96:99], v[152:159], v7
    v_exp_f32 v130, v130
    v_exp_f32 v131, v131
    v_exp_f32 v132, v132
    s_waitcnt lgkmcnt(0)
    v_mfma_f32_32x32x16_bf16 v[144:159], v[116:119], v[112:115], 0
    v_exp_f32 v133, v133
    v_exp_f32 v134, v134
    v_exp_f32 v135, v135
    v_exp_f32 v136, v136
    v_exp_f32 v137, v137
    v_smfmac_f32_32x32x32_bf16 v[160:175], v[120:123], v[128:135], v7
    ds_read_b128 v[116:119], v10 offset:40960
    ds_read_b128 v[120:123], v3 offset:3072
    ds_read_b128 v[96:99], v3 offset:3584
    v_exp_f32 v138, v138
    v_exp_f32 v139, v139
    v_exp_f32 v140, v140
    v_exp_f32 v141, v141
    v_mfma_f32_32x32x16_bf16 v[176:191], v[248:251], v[244:247], v[176:191]
    buffer_load_dwordx4 v[224:227], v2, s[36:39], s46 offen offset:1024 sc1
    s_add_u32 s46, s46, 2048
    v_exp_f32 v142, v142
    v_exp_f32 v143, v143
    v_exp_f32 v144, v144
    v_exp_f32 v145, v145
    v_smfmac_f32_32x32x32_bf16 v[160:175], v[124:127], v[136:143], v7
    v_exp_f32 v146, v146
    v_exp_f32 v147, v147
    v_exp_f32 v148, v148
    s_waitcnt lgkmcnt(0)
    v_mfma_f32_32x32x16_bf16 v[128:143], v[116:119], v[112:115], 0
    v_exp_f32 v149, v149
    v_exp_f32 v150, v150
    v_exp_f32 v151, v151
    v_exp_f32 v152, v152
    v_exp_f32 v153, v153
    v_smfmac_f32_32x32x32_bf16 v[160:175], v[120:123], v[144:151], v7
    ds_read_b128 v[116:119], v10 offset:41984
    v_add_u32 v3, v4, v3
    ds_read_b128 v[120:123], v3 offset:0
    ds_read_b128 v[124:127], v3 offset:512
    v_exp_f32 v154, v154
    v_exp_f32 v155, v155
    v_exp_f32 v156, v156
    v_exp_f32 v157, v157
    v_mfma_f32_32x32x16_bf16 v[192:207], v[252:255], v[244:247], v[192:207]
    buffer_load_dwordx4 v[228:231], v2, s[36:39], s44 offen offset:1024 sc1
    s_add_u32 s44, s44, 2048
    v_exp_f32 v158, v158
    v_exp_f32 v159, v159
    v_exp_f32 v128, v128
    v_exp_f32 v129, v129
    v_smfmac_f32_32x32x32_bf16 v[160:175], v[96:99], v[152:159], v7
    v_exp_f32 v130, v130
    v_exp_f32 v131, v131
    v_exp_f32 v132, v132
    s_waitcnt lgkmcnt(0)
    v_mfma_f32_32x32x16_bf16 v[144:159], v[116:119], v[112:115], 0
    v_exp_f32 v133, v133
    v_exp_f32 v134, v134
    v_exp_f32 v135, v135
    v_exp_f32 v136, v136
    v_exp_f32 v137, v137
    v_smfmac_f32_32x32x32_bf16 v[160:175], v[120:123], v[128:135], v7
    ds_read_b128 v[116:119], v10 offset:43008
    ds_read_b128 v[120:123], v3 offset:1024
    ds_read_b128 v[96:99], v3 offset:1536
    v_exp_f32 v138, v138
    v_exp_f32 v139, v139
    v_exp_f32 v140, v140
    v_exp_f32 v141, v141
    s_waitcnt vmcnt(7)
    v_mfma_f32_32x32x16_bf16 v[176:191], v[36:39], v[32:35], v[176:191]
    buffer_load_dwordx4 v[232:235], v2, s[36:39], s45 offen sc1
    buffer_load_dwordx4 v[236:239], v2, s[36:39], s46 offen sc1
    v_exp_f32 v142, v142
    v_exp_f32 v143, v143
    v_exp_f32 v144, v144
    v_exp_f32 v145, v145
    v_smfmac_f32_32x32x32_bf16 v[160:175], v[124:127], v[136:143], v7
    v_exp_f32 v146, v146
    v_exp_f32 v147, v147
    v_exp_f32 v148, v148
    s_waitcnt lgkmcnt(0)
    v_mfma_f32_32x32x16_bf16 v[128:143], v[116:119], v[112:115], 0
    v_exp_f32 v149, v149
    v_exp_f32 v150, v150
    v_exp_f32 v151, v151
    v_exp_f32 v152, v152
    v_exp_f32 v153, v153
    v_smfmac_f32_32x32x32_bf16 v[160:175], v[120:123], v[144:151], v7
    ds_read_b128 v[116:119], v10 offset:44032
    ds_read_b128 v[120:123], v3 offset:2048
    ds_read_b128 v[124:127], v3 offset:2560
    v_exp_f32 v154, v154
    v_exp_f32 v155, v155
    v_exp_f32 v156, v156
    v_exp_f32 v157, v157
    v_mfma_f32_32x32x16_bf16 v[192:207], v[40:43], v[32:35], v[192:207]
    buffer_load_dwordx4 v[240:243], v2, s[36:39], s44 offen sc1
    buffer_load_dwordx4 v[244:247], v2, s[36:39], s45 offen offset:1024 sc1
    s_add_u32 s45, s45, 2048
    v_exp_f32 v158, v158
    v_exp_f32 v159, v159
    v_exp_f32 v128, v128
    v_exp_f32 v129, v129
    v_smfmac_f32_32x32x32_bf16 v[160:175], v[96:99], v[152:159], v7
    v_exp_f32 v130, v130
    v_exp_f32 v131, v131
    v_exp_f32 v132, v132
    s_waitcnt lgkmcnt(0)
    v_mfma_f32_32x32x16_bf16 v[144:159], v[116:119], v[112:115], 0
    v_exp_f32 v133, v133
    v_exp_f32 v134, v134
    v_exp_f32 v135, v135
    v_exp_f32 v136, v136
    v_exp_f32 v137, v137
    v_smfmac_f32_32x32x32_bf16 v[160:175], v[120:123], v[128:135], v7
    ds_read_b128 v[116:119], v10 offset:45056
    ds_read_b128 v[120:123], v3 offset:3072
    ds_read_b128 v[96:99], v3 offset:3584
    v_exp_f32 v138, v138
    v_exp_f32 v139, v139
    v_exp_f32 v140, v140
    v_exp_f32 v141, v141
    v_mfma_f32_32x32x16_bf16 v[176:191], v[48:51], v[44:47], v[176:191]
    buffer_load_dwordx4 v[248:251], v2, s[36:39], s46 offen offset:1024 sc1
    s_add_u32 s46, s46, 2048
    v_exp_f32 v142, v142
    v_exp_f32 v143, v143
    v_exp_f32 v144, v144
    v_exp_f32 v145, v145
    v_smfmac_f32_32x32x32_bf16 v[160:175], v[124:127], v[136:143], v7
    v_exp_f32 v146, v146
    v_exp_f32 v147, v147
    v_exp_f32 v148, v148
    s_waitcnt lgkmcnt(0)
    v_mfma_f32_32x32x16_bf16 v[128:143], v[116:119], v[112:115], 0
    v_exp_f32 v149, v149
    v_exp_f32 v150, v150
    v_exp_f32 v151, v151
    v_exp_f32 v152, v152
    v_exp_f32 v153, v153
    v_smfmac_f32_32x32x32_bf16 v[160:175], v[120:123], v[144:151], v7
    ds_read_b128 v[116:119], v10 offset:46080
    v_add_u32 v3, v4, v3
    ds_read_b128 v[120:123], v3 offset:0
    ds_read_b128 v[124:127], v3 offset:512
    v_exp_f32 v154, v154
    v_exp_f32 v155, v155
    v_exp_f32 v156, v156
    v_exp_f32 v157, v157
    v_mfma_f32_32x32x16_bf16 v[192:207], v[52:55], v[44:47], v[192:207]
    buffer_load_dwordx4 v[252:255], v2, s[36:39], s44 offen offset:1024 sc1
    s_add_u32 s44, s44, 2048
    v_exp_f32 v158, v158
    v_exp_f32 v159, v159
    v_exp_f32 v128, v128
    v_exp_f32 v129, v129
    v_smfmac_f32_32x32x32_bf16 v[160:175], v[96:99], v[152:159], v7
    v_exp_f32 v130, v130
    v_exp_f32 v131, v131
    v_exp_f32 v132, v132
    s_waitcnt lgkmcnt(0)
    v_mfma_f32_32x32x16_bf16 v[144:159], v[116:119], v[112:115], 0
    v_exp_f32 v133, v133
    v_exp_f32 v134, v134
    v_exp_f32 v135, v135
    v_exp_f32 v136, v136
    v_exp_f32 v137, v137
    v_smfmac_f32_32x32x32_bf16 v[160:175], v[120:123], v[128:135], v7
    ds_read_b128 v[116:119], v10 offset:47104
    ds_read_b128 v[120:123], v3 offset:1024
    ds_read_b128 v[96:99], v3 offset:1536
    v_exp_f32 v138, v138
    v_exp_f32 v139, v139
    v_exp_f32 v140, v140
    v_exp_f32 v141, v141
    s_waitcnt vmcnt(6)
    v_mfma_f32_32x32x16_bf16 v[176:191], v[212:215], v[208:211], v[176:191]
    buffer_load_dwordx4 v[32:35], v2, s[36:39], s51 offen offset:2048 sc1
    v_exp_f32 v142, v142
    v_exp_f32 v143, v143
    v_exp_f32 v144, v144
    v_exp_f32 v145, v145
    v_smfmac_f32_32x32x32_bf16 v[160:175], v[124:127], v[136:143], v7
    v_exp_f32 v146, v146
    v_exp_f32 v147, v147
    v_exp_f32 v148, v148
    s_waitcnt lgkmcnt(0)
    v_mfma_f32_32x32x16_bf16 v[128:143], v[116:119], v[112:115], 0
    v_exp_f32 v149, v149
    v_exp_f32 v150, v150
    v_exp_f32 v151, v151
    v_exp_f32 v152, v152
    v_exp_f32 v153, v153
    v_smfmac_f32_32x32x32_bf16 v[160:175], v[120:123], v[144:151], v7
    ds_read_b128 v[116:119], v10 offset:48128
    ds_read_b128 v[120:123], v3 offset:2048
    ds_read_b128 v[124:127], v3 offset:2560
    v_exp_f32 v154, v154
    v_exp_f32 v155, v155
    v_exp_f32 v156, v156
    v_exp_f32 v157, v157
    v_mfma_f32_32x32x16_bf16 v[192:207], v[216:219], v[208:211], v[192:207]
    buffer_load_dwordx4 v[36:39], v2, s[36:39], s55 offen offset:2048 sc1
    v_exp_f32 v158, v158
    v_exp_f32 v159, v159
    v_exp_f32 v128, v128
    v_exp_f32 v129, v129
    v_smfmac_f32_32x32x32_bf16 v[160:175], v[96:99], v[152:159], v7
    v_exp_f32 v130, v130
    v_exp_f32 v131, v131
    v_exp_f32 v132, v132
    s_waitcnt lgkmcnt(0)
    v_mfma_f32_32x32x16_bf16 v[144:159], v[116:119], v[112:115], 0
    v_exp_f32 v133, v133
    v_exp_f32 v134, v134
    v_exp_f32 v135, v135
    v_exp_f32 v136, v136
    v_exp_f32 v137, v137
    v_smfmac_f32_32x32x32_bf16 v[160:175], v[120:123], v[128:135], v7
    ds_read_b128 v[120:123], v3 offset:3072
    ds_read_b128 v[96:99], v3 offset:3584
    v_exp_f32 v138, v138
    v_exp_f32 v139, v139
    v_exp_f32 v140, v140
    v_exp_f32 v141, v141
    v_mfma_f32_32x32x16_bf16 v[176:191], v[224:227], v[220:223], v[176:191]
    buffer_load_dwordx4 v[40:43], v2, s[36:39], s51 offen offset:3072 sc1
    v_exp_f32 v142, v142
    v_exp_f32 v143, v143
    v_exp_f32 v144, v144
    v_exp_f32 v145, v145
    v_smfmac_f32_32x32x32_bf16 v[160:175], v[124:127], v[136:143], v7
    v_exp_f32 v146, v146
    v_exp_f32 v147, v147
    v_exp_f32 v148, v148
    s_waitcnt lgkmcnt(0)
    v_exp_f32 v149, v149
    v_exp_f32 v150, v150
    v_exp_f32 v151, v151
    v_exp_f32 v152, v152
    v_exp_f32 v153, v153
    v_smfmac_f32_32x32x32_bf16 v[160:175], v[120:123], v[144:151], v7
    v_exp_f32 v154, v154
    v_exp_f32 v155, v155
    v_exp_f32 v156, v156
    v_exp_f32 v157, v157
    v_mfma_f32_32x32x16_bf16 v[192:207], v[228:231], v[220:223], v[192:207]
    buffer_load_dwordx4 v[44:47], v2, s[36:39], s55 offen offset:3072 sc1
    v_exp_f32 v158, v158
    v_exp_f32 v159, v159
    s_nop 0
    s_nop 0
    v_smfmac_f32_32x32x32_bf16 v[160:175], v[96:99], v[152:159], v7
    s_waitcnt vmcnt(4)
    v_mfma_f32_32x32x16_bf16 v[176:191], v[236:239], v[232:235], v[176:191]
    v_mfma_f32_32x32x16_bf16 v[192:207], v[240:243], v[232:235], v[192:207]
    v_mfma_f32_32x32x16_bf16 v[176:191], v[248:251], v[244:247], v[176:191]
    v_mfma_f32_32x32x16_bf16 v[192:207], v[252:255], v[244:247], v[192:207]
    s_nop 6
    v_mov_b32 v25, v168
    s_nop 1
    v_permlane32_swap_b32 v168, v25
    v_mul_f32 v24, 0, v168
    v_fma_f32 v24, v160, 0, v24
    v_fma_f32 v24, v161, 0, v24
    v_fma_f32 v24, v162, 0, v24
    v_fma_f32 v24, v163, 0, v24
    v_fma_f32 v24, v164, 0, v24
    v_fma_f32 v24, v165, 0, v24
    v_fma_f32 v24, v166, 0, v24
    v_fma_f32 v24, v167, 0, v24
    v_add_f32 v24, v24, v168
    v_mov_b32 v25, 0x2f800000
    v_mov_b32 v26, 0x5f800000
    v_cmp_nge_f32 vcc, v24, v25
    v_cmp_nle_f32 s[56:57], v24, v26
    s_nop 3
    s_or_b64 vcc, vcc, s[56:57]
    s_cbranch_scc1 L_slow
L_norm:
    v_rcp_f32 v24, v168
    s_nop 0
    v_mul_f32 v160, v160, v24
    v_mul_f32 v161, v161, v24
    v_mul_f32 v162, v162, v24
    v_mul_f32 v163, v163, v24
    v_mul_f32 v164, v164, v24
    v_mul_f32 v165, v165, v24
    v_mul_f32 v166, v166, v24
    v_mul_f32 v167, v167, v24
    v_cvt_pk_bf16_f32 v16, v160, v161
    v_cvt_pk_bf16_f32 v17, v162, v163
    v_cvt_pk_bf16_f32 v18, v164, v165
    v_cvt_pk_bf16_f32 v19, v166, v167
    buffer_store_dwordx4 v[16:19], v2, s[36:39], s99 offen sc1
    buffer_load_dwordx4 v[100:103], v11, s[20:23], s49 offen
    ds_write_b128 v12, v[176:179] offset:0
    ds_write_b128 v13, v[180:183] offset:0
    ds_write_b128 v14, v[184:187] offset:0
    ds_write_b128 v15, v[188:191] offset:0
    ds_write_b128 v12, v[192:195] offset:128
    ds_write_b128 v13, v[196:199] offset:128
    ds_write_b128 v14, v[200:203] offset:128
    ds_write_b128 v15, v[204:207] offset:128
    s_add_u32 s47, s50, 4096
    s_waitcnt lgkmcnt(0)
    s_barrier
    buffer_load_dwordx4 v[208:211], v2, s[36:39], s50 offen offset:0 sc1
    buffer_load_dwordx4 v[212:215], v2, s[36:39], s50 offen offset:1024 sc1
    buffer_load_dwordx4 v[216:219], v2, s[36:39], s50 offen offset:2048 sc1
    buffer_load_dwordx4 v[220:223], v2, s[36:39], s50 offen offset:3072 sc1
    buffer_load_dwordx4 v[224:227], v2, s[36:39], s47 offen offset:0 sc1
    buffer_load_dwordx4 v[228:231], v2, s[36:39], s47 offen offset:1024 sc1
    buffer_load_dwordx4 v[232:235], v2, s[36:39], s47 offen offset:2048 sc1
    buffer_load_dwordx4 v[236:239], v2, s[36:39], s47 offen offset:3072 sc1
    ds_read_b128 v[128:131], v20 offset:0
    ds_read_b128 v[132:135], v21 offset:0
    ds_read_b128 v[136:139], v20 offset:8192
    ds_read_b128 v[140:143], v21 offset:8192
    ds_read_b128 v[144:147], v20 offset:16384
    ds_read_b128 v[148:151], v21 offset:16384
    ds_read_b128 v[152:155], v20 offset:24576
    ds_read_b128 v[156:159], v21 offset:24576
    v_add_u32 v12, 65536, v12
    v_add_u32 v13, 65536, v13
    v_add_u32 v14, 65536, v14
    v_add_u32 v15, 65536, v15
    s_waitcnt lgkmcnt(4)
    v_add_f32 v128, v128, v136
    v_add_f32 v129, v129, v137
    v_add_f32 v130, v130, v138
    v_add_f32 v131, v131, v139
    v_add_f32 v132, v132, v140
    v_add_f32 v133, v133, v141
    v_add_f32 v134, v134, v142
    v_add_f32 v135, v135, v143
    s_waitcnt lgkmcnt(0)
    v_add_f32 v144, v144, v152
    v_add_f32 v145, v145, v153
    v_add_f32 v146, v146, v154
    v_add_f32 v147, v147, v155
    v_add_f32 v148, v148, v156
    v_add_f32 v149, v149, v157
    v_add_f32 v150, v150, v158
    v_add_f32 v151, v151, v159
    v_add_f32 v128, v128, v144
    v_add_f32 v129, v129, v145
    v_add_f32 v130, v130, v146
    v_add_f32 v131, v131, v147
    v_add_f32 v132, v132, v148
    v_add_f32 v133, v133, v149
    v_add_f32 v134, v134, v150
    v_add_f32 v135, v135, v151
    v_mul_f32 v136, 0xbfb8aa3b, v128
    v_mul_f32 v137, 0xbfb8aa3b, v129
    v_mul_f32 v138, 0xbfb8aa3b, v130
    v_mul_f32 v139, 0xbfb8aa3b, v131
    v_mul_f32 v140, 0xbfb8aa3b, v132
    v_mul_f32 v141, 0xbfb8aa3b, v133
    v_mul_f32 v142, 0xbfb8aa3b, v134
    v_mul_f32 v143, 0xbfb8aa3b, v135
    v_exp_f32 v136, v136
    v_exp_f32 v137, v137
    v_exp_f32 v138, v138
    v_exp_f32 v139, v139
    v_exp_f32 v140, v140
    v_exp_f32 v141, v141
    v_exp_f32 v142, v142
    v_exp_f32 v143, v143
    v_add_u32 v20, 65536, v20
    v_add_u32 v21, 65536, v21
    v_add_f32 v136, 1.0, v136
    v_add_f32 v137, 1.0, v137
    v_add_f32 v138, 1.0, v138
    v_add_f32 v139, 1.0, v139
    v_add_f32 v140, 1.0, v140
    v_add_f32 v141, 1.0, v141
    v_add_f32 v142, 1.0, v142
    v_add_f32 v143, 1.0, v143
    v_rcp_f32 v136, v136
    v_rcp_f32 v137, v137
    v_rcp_f32 v138, v138
    v_rcp_f32 v139, v139
    v_rcp_f32 v140, v140
    v_rcp_f32 v141, v141
    v_rcp_f32 v142, v142
    v_rcp_f32 v143, v143
    v_mul_f32 v128, v128, v136
    v_mul_f32 v129, v129, v137
    v_mul_f32 v130, v130, v138
    v_mul_f32 v131, v131, v139
    v_mul_f32 v132, v132, v140
    v_mul_f32 v133, v133, v141
    v_mul_f32 v134, v134, v142
    v_mul_f32 v135, v135, v143
    s_waitcnt vmcnt(7)
    v_mfma_f32_32x32x16_bf16 v[160:175], v[56:59], v[208:211], 0
    v_mfma_f32_32x32x16_bf16 v[176:191], v[60:63], v[208:211], 0
    s_waitcnt vmcnt(6)
    v_mfma_f32_32x32x16_bf16 v[160:175], v[64:67], v[212:215], v[160:175]
    v_mfma_f32_32x32x16_bf16 v[176:191], v[68:71], v[212:215], v[176:191]
    s_waitcnt vmcnt(5)
    v_mfma_f32_32x32x16_bf16 v[160:175], v[72:75], v[216:219], v[160:175]
    v_mfma_f32_32x32x16_bf16 v[176:191], v[76:79], v[216:219], v[176:191]
    s_waitcnt vmcnt(4)
    v_mfma_f32_32x32x16_bf16 v[160:175], v[80:83], v[220:223], v[160:175]
    v_mfma_f32_32x32x16_bf16 v[176:191], v[84:87], v[220:223], v[176:191]
    s_waitcnt vmcnt(3)
    v_mfma_f32_32x32x16_bf16 v[160:175], v[88:91], v[224:227], v[160:175]
    v_mfma_f32_32x32x16_bf16 v[176:191], v[92:95], v[224:227], v[176:191]
    s_waitcnt vmcnt(2)
    v_mfma_f32_32x32x16_bf16 v[160:175], v[104:107], v[228:231], v[160:175]
    v_mfma_f32_32x32x16_bf16 v[176:191], v[108:111], v[228:231], v[176:191]
    s_waitcnt vmcnt(1)
    v_mfma_f32_32x32x16_bf16 v[160:175], v[32:35], v[232:235], v[160:175]
    v_mfma_f32_32x32x16_bf16 v[176:191], v[36:39], v[232:235], v[176:191]
    s_waitcnt vmcnt(0)
    v_mfma_f32_32x32x16_bf16 v[160:175], v[40:43], v[236:239], v[160:175]
    v_mfma_f32_32x32x16_bf16 v[176:191], v[44:47], v[236:239], v[176:191]
    v_max3_u32 v24, v208, v209, v210
    v_max3_u32 v24, v211, v212, v24
    v_max3_u32 v24, v213, v214, v24
    v_max3_u32 v24, v215, v216, v24
    v_max3_u32 v24, v217, v218, v24
    v_max3_u32 v24, v219, v220, v24
    v_max3_u32 v24, v221, v222, v24
    v_max3_u32 v24, v223, v224, v24
    v_max3_u32 v24, v225, v226, v24
    v_max3_u32 v24, v227, v228, v24
    v_max3_u32 v24, v229, v230, v24
    v_max3_u32 v24, v231, v232, v24
    v_max3_u32 v24, v233, v234, v24
    v_max3_u32 v24, v235, v236, v24
    v_max3_u32 v24, v237, v238, v24
    v_max_u32 v24, v239, v24
    v_cmp_eq_u32 vcc, -1, v24
    s_nop 4
    s_cbranch_vccz L_odone
    s_mov_b32 s98, 0
L_opoll:
    buffer_load_dwordx4 v[208:211], v2, s[36:39], s50 offen offset:0 sc1
    buffer_load_dwordx4 v[212:215], v2, s[36:39], s50 offen offset:1024 sc1
    buffer_load_dwordx4 v[216:219], v2, s[36:39], s50 offen offset:2048 sc1
    buffer_load_dwordx4 v[220:223], v2, s[36:39], s50 offen offset:3072 sc1
    buffer_load_dwordx4 v[224:227], v2, s[36:39], s47 offen offset:0 sc1
    buffer_load_dwordx4 v[228:231], v2, s[36:39], s47 offen offset:1024 sc1
    buffer_load_dwordx4 v[232:235], v2, s[36:39], s47 offen offset:2048 sc1
    buffer_load_dwordx4 v[236:239], v2, s[36:39], s47 offen offset:3072 sc1
    s_waitcnt vmcnt(0)
    v_max3_u32 v24, v208, v209, v210
    v_max3_u32 v24, v211, v212, v24
    v_max3_u32 v24, v213, v214, v24
    v_max3_u32 v24, v215, v216, v24
    v_max3_u32 v24, v217, v218, v24
    v_max3_u32 v24, v219, v220, v24
    v_max3_u32 v24, v221, v222, v24
    v_max3_u32 v24, v223, v224, v24
    v_max3_u32 v24, v225, v226, v24
    v_max3_u32 v24, v227, v228, v24
    v_max3_u32 v24, v229, v230, v24
    v_max3_u32 v24, v231, v232, v24
    v_max3_u32 v24, v233, v234, v24
    v_max3_u32 v24, v235, v236, v24
    v_max3_u32 v24, v237, v238, v24
    v_max_u32 v24, v239, v24
    v_cmp_eq_u32 vcc, -1, v24
    s_add_u32 s98, s98, 1
    s_cmp_gt_u32 s98, 200000
    s_cbranch_scc1 L_oready
    s_nop 1
    s_cbranch_vccnz L_opoll
L_oready:
    v_mfma_f32_32x32x16_bf16 v[160:175], v[56:59], v[208:211], 0
    v_mfma_f32_32x32x16_bf16 v[176:191], v[60:63], v[208:211], 0
    v_mfma_f32_32x32x16_bf16 v[160:175], v[64:67], v[212:215], v[160:175]
    v_mfma_f32_32x32x16_bf16 v[176:191], v[68:71], v[212:215], v[176:191]
    v_mfma_f32_32x32x16_bf16 v[160:175], v[72:75], v[216:219], v[160:175]
    v_mfma_f32_32x32x16_bf16 v[176:191], v[76:79], v[216:219], v[176:191]
    v_mfma_f32_32x32x16_bf16 v[160:175], v[80:83], v[220:223], v[160:175]
    v_mfma_f32_32x32x16_bf16 v[176:191], v[84:87], v[220:223], v[176:191]
    v_mfma_f32_32x32x16_bf16 v[160:175], v[88:91], v[224:227], v[160:175]
    v_mfma_f32_32x32x16_bf16 v[176:191], v[92:95], v[224:227], v[176:191]
    v_mfma_f32_32x32x16_bf16 v[160:175], v[104:107], v[228:231], v[160:175]
    v_mfma_f32_32x32x16_bf16 v[176:191], v[108:111], v[228:231], v[176:191]
    v_mfma_f32_32x32x16_bf16 v[160:175], v[32:35], v[232:235], v[160:175]
    v_mfma_f32_32x32x16_bf16 v[176:191], v[36:39], v[232:235], v[176:191]
    v_mfma_f32_32x32x16_bf16 v[160:175], v[40:43], v[236:239], v[160:175]
    v_mfma_f32_32x32x16_bf16 v[176:191], v[44:47], v[236:239], v[176:191]
L_odone:
    s_mov_b32 s24, s18
    s_mov_b32 s25, s19
    s_mov_b32 s26, 0x200000
    s_mov_b32 s27, 0x20000
    v_lshlrev_b32 v112, 16, v100
    v_and_b32 v113, 0xffff0000, v100
    v_lshlrev_b32 v114, 16, v101
    v_and_b32 v115, 0xffff0000, v101
    v_lshlrev_b32 v116, 16, v102
    v_and_b32 v117, 0xffff0000, v102
    v_lshlrev_b32 v118, 16, v103
    v_and_b32 v119, 0xffff0000, v103
    ds_write_b128 v12, v[160:163] offset:0
    ds_write_b128 v13, v[164:167] offset:0
    ds_write_b128 v14, v[168:171] offset:0
    ds_write_b128 v15, v[172:175] offset:0
    ds_write_b128 v12, v[176:179] offset:128
    ds_write_b128 v13, v[180:183] offset:128
    ds_write_b128 v14, v[184:187] offset:128
    ds_write_b128 v15, v[188:191] offset:128
    s_waitcnt lgkmcnt(0)
    s_barrier
    ds_read_b128 v[144:147], v20 offset:0
    ds_read_b128 v[148:151], v21 offset:0
    ds_read_b128 v[152:155], v20 offset:8192
    ds_read_b128 v[156:159], v21 offset:8192
    ds_read_b128 v[160:163], v20 offset:16384
    ds_read_b128 v[164:167], v21 offset:16384
    ds_read_b128 v[168:171], v20 offset:24576
    ds_read_b128 v[172:175], v21 offset:24576
    s_waitcnt lgkmcnt(4)
    v_add_f32 v144, v144, v152
    v_add_f32 v145, v145, v153
    v_add_f32 v146, v146, v154
    v_add_f32 v147, v147, v155
    v_add_f32 v148, v148, v156
    v_add_f32 v149, v149, v157
    v_add_f32 v150, v150, v158
    v_add_f32 v151, v151, v159
    s_waitcnt lgkmcnt(0)
    v_add_f32 v160, v160, v168
    v_add_f32 v161, v161, v169
    v_add_f32 v162, v162, v170
    v_add_f32 v163, v163, v171
    v_add_f32 v164, v164, v172
    v_add_f32 v165, v165, v173
    v_add_f32 v166, v166, v174
    v_add_f32 v167, v167, v175
    v_add_f32 v144, v144, v160
    v_add_f32 v145, v145, v161
    v_add_f32 v146, v146, v162
    v_add_f32 v147, v147, v163
    v_add_f32 v148, v148, v164
    v_add_f32 v149, v149, v165
    v_add_f32 v150, v150, v166
    v_add_f32 v151, v151, v167
    v_fma_f32 v144, v144, v128, v112
    v_fma_f32 v145, v145, v129, v113
    v_fma_f32 v146, v146, v130, v114
    v_fma_f32 v147, v147, v131, v115
    v_fma_f32 v148, v148, v132, v116
    v_fma_f32 v149, v149, v133, v117
    v_fma_f32 v150, v150, v134, v118
    v_fma_f32 v151, v151, v135, v119
    v_cvt_pk_bf16_f32 v168, v144, v145
    v_cvt_pk_bf16_f32 v169, v146, v147
    v_cvt_pk_bf16_f32 v170, v148, v149
    v_cvt_pk_bf16_f32 v171, v150, v151
    buffer_store_dwordx4 v[168:171], v11, s[24:27], s49 offen
    s_endpgm
L_slow:
    s_waitcnt vmcnt(0) lgkmcnt(0)
    s_nop 15
    v_mov_b32 v24, 0xff800000
    s_lshl_b32 s67, s93, 16
    s_add_u32 s66, s67, 0x200000
    s_mov_b32 s65, 64
L_slow1:
    buffer_load_dwordx4 v[116:119], v2, s[36:39], s66 offen sc1
    s_add_u32 s66, s66, 1024
    s_sub_u32 s65, s65, 1
    s_waitcnt vmcnt(0)
    v_mfma_f32_32x32x16_bf16 v[128:143], v[116:119], v[112:115], 0
    s_nop 15
    v_max3_f32 v24, v128, v129, v24
    v_max3_f32 v24, v130, v131, v24
    v_max3_f32 v24, v132, v133, v24
    v_max3_f32 v24, v134, v135, v24
    v_max3_f32 v24, v136, v137, v24
    v_max3_f32 v24, v138, v139, v24
    v_max3_f32 v24, v140, v141, v24
    v_max3_f32 v24, v142, v143, v24
    s_cmp_lg_u32 s65, 0
    s_cbranch_scc1 L_slow1
    v_mov_b32 v27, v24
    s_nop 1
    v_permlane32_swap_b32 v24, v27
    s_nop 1
    v_max_f32 v24, v24, v27
    v_mov_b32 v160, 0
    v_mov_b32 v161, 0
    v_mov_b32 v162, 0
    v_mov_b32 v163, 0
    v_mov_b32 v164, 0
    v_mov_b32 v165, 0
    v_mov_b32 v166, 0
    v_mov_b32 v167, 0
    v_mov_b32 v168, 0
    v_mov_b32 v169, 0
    v_mov_b32 v170, 0
    v_mov_b32 v171, 0
    v_mov_b32 v172, 0
    v_mov_b32 v173, 0
    v_mov_b32 v174, 0
    v_mov_b32 v175, 0
    v_bfe_u32 v26, v2, 4, 4
    v_lshlrev_b32 v26, 4, v26
    v_lshrrev_b32 v27, 9, v2
    v_lshl_add_u32 v26, v27, 8, v26
    s_add_u32 s66, s67, 0x200000
    s_add_u32 s67, s67, 0x400000
    s_mov_b32 s65, 64
L_slow2:
    buffer_load_dwordx4 v[116:119], v2, s[36:39], s66 offen sc1
    s_mov_b32 exec_lo, 0xffff
    s_mov_b32 exec_hi, 0xffff
    buffer_load_dwordx4 v[120:123], v26, s[36:39], s67 offen sc1
    buffer_load_dwordx4 v[124:127], v26, s[36:39], s67 offen offset:512 sc1
    s_mov_b64 exec, -1
    s_add_u32 s66, s66, 1024
    s_add_u32 s67, s67, 1024
    s_sub_u32 s65, s65, 1
    s_waitcnt vmcnt(0)
    v_mfma_f32_32x32x16_bf16 v[128:143], v[116:119], v[112:115], 0
    s_nop 15
    v_sub_f32 v128, v128, v24
    v_sub_f32 v129, v129, v24
    v_sub_f32 v130, v130, v24
    v_sub_f32 v131, v131, v24
    v_sub_f32 v132, v132, v24
    v_sub_f32 v133, v133, v24
    v_sub_f32 v134, v134, v24
    v_sub_f32 v135, v135, v24
    v_sub_f32 v136, v136, v24
    v_sub_f32 v137, v137, v24
    v_sub_f32 v138, v138, v24
    v_sub_f32 v139, v139, v24
    v_sub_f32 v140, v140, v24
    v_sub_f32 v141, v141, v24
    v_sub_f32 v142, v142, v24
    v_sub_f32 v143, v143, v24
    v_exp_f32 v128, v128
    v_exp_f32 v129, v129
    v_exp_f32 v130, v130
    v_exp_f32 v131, v131
    v_exp_f32 v132, v132
    v_exp_f32 v133, v133
    v_exp_f32 v134, v134
    v_exp_f32 v135, v135
    v_exp_f32 v136, v136
    v_exp_f32 v137, v137
    v_exp_f32 v138, v138
    v_exp_f32 v139, v139
    v_exp_f32 v140, v140
    v_exp_f32 v141, v141
    v_exp_f32 v142, v142
    v_exp_f32 v143, v143
    s_nop 1
    v_smfmac_f32_32x32x32_bf16 v[160:175], v[120:123], v[128:135], v7
    v_smfmac_f32_32x32x32_bf16 v[160:175], v[124:127], v[136:143], v7
    s_cmp_lg_u32 s65, 0
    s_cbranch_scc1 L_slow2
    s_nop 15
    v_mov_b32 v25, v168
    s_nop 1
    v_permlane32_swap_b32 v168, v25
    s_nop 1
    s_branch L_norm
L_end:
    s_endpgm
.section .rodata,"a"
.p2align 6
.amdhsa_kernel recurrent_scan__mha_block__swiglu_ffn__prompt_kernel
  .amdhsa_next_free_vgpr 256
  .amdhsa_next_free_sgpr 102
  .amdhsa_accum_offset 256
  .amdhsa_group_segment_fixed_size 0
  .amdhsa_kernarg_size 80
  .amdhsa_user_sgpr_count 2
  .amdhsa_user_sgpr_kernarg_segment_ptr 1
  .amdhsa_system_sgpr_workgroup_id_x 1
.end_amdhsa_kernel
```
